```python
import torch

def _softmax(x, axis=-1):
    return torch.softmax(x, dim=axis)
def _gelu(x):
    return torch.nn.functional.gelu(x, approximate="tanh")
def _silu(x):
    return torch.nn.functional.silu(x)
def _sigmoid(x):
    return torch.sigmoid(x)
def _layernorm(x, axis=-1, eps=1e-5):
    m = x.mean(dim=axis, keepdim=True)
    v = x.var(dim=axis, keepdim=True, unbiased=False)
    return (x - m) / torch.sqrt(v + eps)
def _scatter_add(tgt, idx, src, axis=0):
    return tgt.clone().index_add_(axis, idx, src)
def _segment_sum(src, seg, n):
    out = torch.zeros((n,) + src.shape[1:], dtype=src.dtype)
    return out.index_add_(0, seg, src)
def _pad(x, pw):
    flat = tuple(v for pair in reversed(pw) for v in pair)
    return torch.nn.functional.pad(x, flat)

kernel_name = 'standalone__gqa_block_cached__near_ridge'

def setup_inputs():

    _w = (lambda a: (lambda t: t.to(torch.bfloat16) if t.is_floating_point() else t)(torch.as_tensor(a)))
    B, Sq, D = 8, 96, 576
    Hq, Hkv, Sk, Dh = 32, 16, 512, 128
    assert Hq % Hkv == 0, (Hq, Hkv)
    return {
        "x": _w((lambda *s: torch.randn(*s, dtype=torch.bfloat16) * 0.8)(B, Sq, D)),
        "k_cache": _w((lambda *s: torch.randn(*s, dtype=torch.bfloat16) * 0.8)(B, Hkv, Sk, Dh)),
        "v_cache": _w((lambda *s: torch.randn(*s, dtype=torch.bfloat16) * 0.05)(B, Hkv, Sk, Dh)),
        "wq": _w((lambda *s: torch.randn(*s, dtype=torch.bfloat16) * 0.8)(D, Hq * Dh) * (D ** -0.5)),
        "wo": _w((lambda *s: torch.randn(*s, dtype=torch.bfloat16) * 0.05)(Hq * Dh, D) * ((Hq * Dh) ** -0.5)),
    }

def reference(x, k_cache, v_cache, wq, wo):
    B, Sq, D = x.shape
    Hq, Dh = 32, 128
    Hkv = k_cache.shape[1]
    rep = Hq // Hkv
    q = (lambda x, *d: x.permute(*d))((x @ wq).reshape(B, Sq, Hq, Dh), 0, 2, 1, 3)
    k = (lambda x, n, axis: torch.repeat_interleave(x, n, dim=axis))(k_cache, rep, axis=1)
    v = (lambda x, n, axis: torch.repeat_interleave(x, n, dim=axis))(v_cache, rep, axis=1)
    scores = torch.einsum("bhqd,bhkd->bhqk", q, k) * (Dh ** -0.5)
    p = _softmax(scores, axis=-1)
    o = torch.einsum("bhqk,bhkd->bhqd", p, v)
    return (lambda x, *d: x.permute(*d))(o, 0, 2, 1, 3).reshape(B, Sq, Hq * Dh) @ wo
```

```asm
; @launch grid=(256,1,1) block=(256,1,1) lds=163840
.amdgcn_target "amdgcn-amd-amdhsa--gfx950"
.text
.globl standalone__gqa_block_cached__near_ridge_kernel
.p2align 8
.type standalone__gqa_block_cached__near_ridge_kernel,@function
standalone__gqa_block_cached__near_ridge_kernel:
    s_load_dwordx16 s[4:19], s[0:1], 0
    s_cmp_ge_u32 s2, 256
    s_cbranch_scc1 L_end
    s_getpc_b64 s[26:27]
L_pc0:
    v_lshlrev_b32 v252, 7, v0
    v_min_u32 v252, L_codeend-L_pc0-4, v252
    v_mov_b32 v253, s27
    v_add_co_u32 v252, vcc, s26, v252
    v_lshrrev_b32 v1, 6, v0
    s_nop 0
    v_addc_co_u32 v253, vcc, 0, v253, vcc
    global_load_dword a131, v[252:253], off
L_nopf:
    s_and_b32 s20, s2, 7
    v_readfirstlane_b32 s25, v1
    s_bfe_u32 s22, s2, 0x20003
    s_lshr_b32 s23, s2, 5
    s_lshl2_add_u32 s24, s20, s22
    v_and_b32 v0, 63, v0
    s_cmp_lg_u32 s25, 0
    s_cbranch_scc1 L_compute
    v_lshrrev_b32 v40, 4, v0
    v_and_b32 v41, 15, v0
    v_lshrrev_b32 v42, 3, v0
    v_and_b32 v43, 7, v0
    v_mul_u32_u24 v42, 1152, v42
    v_add_u32 v2, 0, v40
    v_xor_b32 v2, v2, v43
    v_lshl_add_u32 v2, v2, 4, v42
    v_add_u32 v3, 4, v40
    v_xor_b32 v3, v3, v43
    v_lshl_add_u32 v3, v3, 4, v42
    v_add_u32 v3, 8192, v3
    v_add_u32 v4, 16384, v2
    v_add_u32 v5, 16384, v3
    v_lshlrev_b32 v42, 2, v40
    v_xor_b32 v42, v42, v41
    v_lshlrev_b32 v42, 4, v42
    v_lshl_add_u32 v6, v40, 13, v42
    v_add_u32 v7, 31744, v6
    v_add_u32 v8, 63488, v6
    v_add_u32 v9, 95232, v6
    s_add_u32 s54, s22, s23
    s_mul_i32 s54, s54, 3
    s_add_u32 s54, s54, s20
    s_mul_i32 s55, s54, 57
    s_lshr_b32 s55, s55, 9
    s_mul_i32 s55, s55, 9
    s_sub_u32 s54, s54, s55
    s_mov_b32 s52, 0
    s_mov_b32 s53, 0
    s_mul_i32 s55, s23, 110592
    s_lshl_b32 s56, s24, 8
    s_mov_b32 s30, 110592
    s_mov_b32 s31, 0x00020000
    s_sub_u32 s42, 4718592, s56
    s_mov_b32 s43, 0x00020000
    s_waitcnt lgkmcnt(0)
    s_add_u32 s28, s4, s55
    s_addc_u32 s29, s5, 0
    s_add_u32 s40, s10, s56
    s_addc_u32 s41, s11, 0
L_l0:
    s_lshl_b32 s55, s54, 7
    s_lshl_b32 s56, s54, 19
    s_add_u32 m0, s53, 12288
    s_nop 0
    buffer_load_dwordx4 v6, s[40:43], s56 offen offset:0 lds
    buffer_load_dwordx4 v7, s[40:43], s56 offen offset:1024 lds
    buffer_load_dwordx4 v8, s[40:43], s56 offen offset:2048 lds
    buffer_load_dwordx4 v9, s[40:43], s56 offen offset:3072 lds
    s_add_u32 m0, s53, 0
    s_nop 0
    buffer_load_dwordx4 v2, s[28:31], s55 offen offset:0 lds
    buffer_load_dwordx4 v3, s[28:31], s55 offen offset:1024 lds
    buffer_load_dwordx4 v4, s[28:31], s55 offen offset:2048 lds
    buffer_load_dwordx4 v5, s[28:31], s55 offen offset:3072 lds
    s_add_u32 m0, s53, 16384
    s_add_u32 s56, s56, 131072
    buffer_load_dwordx4 v6, s[40:43], s56 offen offset:0 lds
    buffer_load_dwordx4 v7, s[40:43], s56 offen offset:1024 lds
    buffer_load_dwordx4 v8, s[40:43], s56 offen offset:2048 lds
    buffer_load_dwordx4 v9, s[40:43], s56 offen offset:3072 lds
    s_add_u32 m0, s53, 4096
    s_add_u32 s55, s55, 36864
    buffer_load_dwordx4 v2, s[28:31], s55 offen offset:0 lds
    buffer_load_dwordx4 v3, s[28:31], s55 offen offset:1024 lds
    buffer_load_dwordx4 v4, s[28:31], s55 offen offset:2048 lds
    buffer_load_dwordx4 v5, s[28:31], s55 offen offset:3072 lds
    s_add_u32 m0, s53, 20480
    s_add_u32 s56, s56, 131072
    buffer_load_dwordx4 v6, s[40:43], s56 offen offset:0 lds
    buffer_load_dwordx4 v7, s[40:43], s56 offen offset:1024 lds
    buffer_load_dwordx4 v8, s[40:43], s56 offen offset:2048 lds
    buffer_load_dwordx4 v9, s[40:43], s56 offen offset:3072 lds
    s_add_u32 m0, s53, 8192
    s_add_u32 s55, s55, 36864
    buffer_load_dwordx4 v2, s[28:31], s55 offen offset:0 lds
    buffer_load_dwordx4 v3, s[28:31], s55 offen offset:1024 lds
    buffer_load_dwordx4 v4, s[28:31], s55 offen offset:2048 lds
    buffer_load_dwordx4 v5, s[28:31], s55 offen offset:3072 lds
    s_add_u32 m0, s53, 24576
    s_add_u32 s56, s56, 131072
    buffer_load_dwordx4 v6, s[40:43], s56 offen offset:0 lds
    buffer_load_dwordx4 v7, s[40:43], s56 offen offset:1024 lds
    buffer_load_dwordx4 v8, s[40:43], s56 offen offset:2048 lds
    buffer_load_dwordx4 v9, s[40:43], s56 offen offset:3072 lds
    s_add_u32 s54, s54, 1
    s_cmp_eq_u32 s54, 9
    s_cselect_b32 s54, 0, s54
    s_add_u32 s53, s53, 32768
    s_cmp_eq_u32 s53, 163840
    s_cselect_b32 s53, 0, s53
    s_add_u32 s52, s52, 1
    s_cmp_lt_u32 s52, 2
    s_cbranch_scc1 L_l0
    v_lshl_add_u32 v14, v40, 8, v42
    v_add_u32 v10, 0, v40
    v_xor_b32 v10, v10, v41
    v_lshlrev_b32 v10, 4, v10
    v_lshl_add_u32 v10, v40, 8, v10
    v_add_u32 v11, 4, v40
    v_xor_b32 v11, v11, v41
    v_lshlrev_b32 v11, 4, v11
    v_lshl_add_u32 v11, v40, 8, v11
    v_add_u32 v12, 8, v40
    v_xor_b32 v12, v12, v41
    v_lshlrev_b32 v12, 4, v12
    v_lshl_add_u32 v12, v40, 8, v12
    v_add_u32 v13, 12, v40
    v_xor_b32 v13, v13, v41
    v_lshlrev_b32 v13, 4, v13
    v_lshl_add_u32 v13, v40, 8, v13
    s_lshr_b32 s55, s24, 1
    s_lshl4_add_u32 s55, s23, s55
    s_lshl_b32 s55, s55, 17
    s_add_u32 s32, s6, s55
    s_addc_u32 s33, s7, 0
    s_mov_b32 s34, 131072
    s_mov_b32 s35, 0x00020000
    s_add_u32 s36, s8, s55
    s_addc_u32 s37, s9, 0
    s_mov_b32 s38, 131072
    s_mov_b32 s39, 0x00020000
    s_add_u32 s57, s23, s20
    s_and_b32 s57, s57, 7
    s_lshl_b32 s57, s57, 14
    s_mov_b32 s58, s57
L_lx:
    s_cmp_lt_u32 s52, 3
    s_cbranch_scc1 L_lx_issue
    s_waitcnt vmcnt(56)
    s_barrier
L_lx_issue:
    s_lshl_b32 s55, s54, 7
    s_lshl_b32 s56, s54, 19
    s_add_u32 m0, s53, 12288
    s_nop 0
    buffer_load_dwordx4 v6, s[40:43], s56 offen offset:0 lds
    buffer_load_dwordx4 v7, s[40:43], s56 offen offset:1024 lds
    buffer_load_dwordx4 v8, s[40:43], s56 offen offset:2048 lds
    buffer_load_dwordx4 v9, s[40:43], s56 offen offset:3072 lds
    s_add_u32 m0, s53, 0
    s_nop 0
    buffer_load_dwordx4 v2, s[28:31], s55 offen offset:0 lds
    buffer_load_dwordx4 v3, s[28:31], s55 offen offset:1024 lds
    buffer_load_dwordx4 v4, s[28:31], s55 offen offset:2048 lds
    buffer_load_dwordx4 v5, s[28:31], s55 offen offset:3072 lds
    s_add_u32 m0, s53, 16384
    s_add_u32 s56, s56, 131072
    buffer_load_dwordx4 v6, s[40:43], s56 offen offset:0 lds
    buffer_load_dwordx4 v7, s[40:43], s56 offen offset:1024 lds
    buffer_load_dwordx4 v8, s[40:43], s56 offen offset:2048 lds
    buffer_load_dwordx4 v9, s[40:43], s56 offen offset:3072 lds
    s_add_u32 m0, s53, 4096
    s_add_u32 s55, s55, 36864
    buffer_load_dwordx4 v2, s[28:31], s55 offen offset:0 lds
    buffer_load_dwordx4 v3, s[28:31], s55 offen offset:1024 lds
    buffer_load_dwordx4 v4, s[28:31], s55 offen offset:2048 lds
    buffer_load_dwordx4 v5, s[28:31], s55 offen offset:3072 lds
    s_add_u32 m0, s53, 20480
    s_add_u32 s56, s56, 131072
    buffer_load_dwordx4 v6, s[40:43], s56 offen offset:0 lds
    buffer_load_dwordx4 v7, s[40:43], s56 offen offset:1024 lds
    buffer_load_dwordx4 v8, s[40:43], s56 offen offset:2048 lds
    buffer_load_dwordx4 v9, s[40:43], s56 offen offset:3072 lds
    s_add_u32 m0, s53, 8192
    s_add_u32 s55, s55, 36864
    buffer_load_dwordx4 v2, s[28:31], s55 offen offset:0 lds
    buffer_load_dwordx4 v3, s[28:31], s55 offen offset:1024 lds
    buffer_load_dwordx4 v4, s[28:31], s55 offen offset:2048 lds
    buffer_load_dwordx4 v5, s[28:31], s55 offen offset:3072 lds
    s_add_u32 m0, s53, 24576
    s_add_u32 s56, s56, 131072
    buffer_load_dwordx4 v6, s[40:43], s56 offen offset:0 lds
    buffer_load_dwordx4 v7, s[40:43], s56 offen offset:1024 lds
    buffer_load_dwordx4 v8, s[40:43], s56 offen offset:2048 lds
    buffer_load_dwordx4 v9, s[40:43], s56 offen offset:3072 lds
    s_add_u32 s54, s54, 1
    s_cmp_eq_u32 s54, 9
    s_cselect_b32 s54, 0, s54
    s_add_u32 s53, s53, 32768
    s_cmp_eq_u32 s53, 163840
    s_cselect_b32 s53, 0, s53
    s_add_u32 s52, s52, 1
    s_cmp_lt_u32 s52, 9
    s_cbranch_scc1 L_lx
    s_add_u32 m0, s53, 0
    s_add_u32 s55, s57, 0
    buffer_load_dwordx4 v10, s[32:35], s55 offen offset:0 nt lds
    buffer_load_dwordx4 v11, s[32:35], s55 offen offset:1024 nt lds
    buffer_load_dwordx4 v12, s[32:35], s55 offen offset:2048 nt lds
    buffer_load_dwordx4 v13, s[32:35], s55 offen offset:3072 nt lds
    s_add_u32 m0, s53, 4096
    s_add_u32 s55, s57, 4096
    buffer_load_dwordx4 v10, s[32:35], s55 offen offset:0 nt lds
    buffer_load_dwordx4 v11, s[32:35], s55 offen offset:1024 nt lds
    buffer_load_dwordx4 v12, s[32:35], s55 offen offset:2048 nt lds
    buffer_load_dwordx4 v13, s[32:35], s55 offen offset:3072 nt lds
    s_add_u32 m0, s53, 8192
    s_add_u32 s55, s57, 8192
    buffer_load_dwordx4 v10, s[32:35], s55 offen offset:0 nt lds
    buffer_load_dwordx4 v11, s[32:35], s55 offen offset:1024 nt lds
    buffer_load_dwordx4 v12, s[32:35], s55 offen offset:2048 nt lds
    buffer_load_dwordx4 v13, s[32:35], s55 offen offset:3072 nt lds
    s_add_u32 m0, s53, 12288
    s_add_u32 s55, s57, 12288
    buffer_load_dwordx4 v10, s[32:35], s55 offen offset:0 nt lds
    buffer_load_dwordx4 v11, s[32:35], s55 offen offset:1024 nt lds
    buffer_load_dwordx4 v12, s[32:35], s55 offen offset:2048 nt lds
    buffer_load_dwordx4 v13, s[32:35], s55 offen offset:3072 nt lds
    s_add_u32 s57, s57, 16384
    s_and_b32 s57, s57, 0x1ffff
    s_add_u32 s53, s53, 32768
    s_cmp_eq_u32 s53, 163840
    s_cselect_b32 s53, 0, s53
    s_add_u32 s52, s52, 1
    s_waitcnt vmcnt(63)
    s_barrier
    s_add_u32 m0, s53, 0
    s_add_u32 s55, s57, 0
    buffer_load_dwordx4 v10, s[32:35], s55 offen offset:0 nt lds
    buffer_load_dwordx4 v11, s[32:35], s55 offen offset:1024 nt lds
    buffer_load_dwordx4 v12, s[32:35], s55 offen offset:2048 nt lds
    buffer_load_dwordx4 v13, s[32:35], s55 offen offset:3072 nt lds
    s_add_u32 m0, s53, 4096
    s_add_u32 s55, s57, 4096
    buffer_load_dwordx4 v10, s[32:35], s55 offen offset:0 nt lds
    buffer_load_dwordx4 v11, s[32:35], s55 offen offset:1024 nt lds
    buffer_load_dwordx4 v12, s[32:35], s55 offen offset:2048 nt lds
    buffer_load_dwordx4 v13, s[32:35], s55 offen offset:3072 nt lds
    s_add_u32 m0, s53, 8192
    s_add_u32 s55, s57, 8192
    buffer_load_dwordx4 v10, s[32:35], s55 offen offset:0 nt lds
    buffer_load_dwordx4 v11, s[32:35], s55 offen offset:1024 nt lds
    buffer_load_dwordx4 v12, s[32:35], s55 offen offset:2048 nt lds
    buffer_load_dwordx4 v13, s[32:35], s55 offen offset:3072 nt lds
    s_add_u32 m0, s53, 12288
    s_add_u32 s55, s57, 12288
    buffer_load_dwordx4 v10, s[32:35], s55 offen offset:0 nt lds
    buffer_load_dwordx4 v11, s[32:35], s55 offen offset:1024 nt lds
    buffer_load_dwordx4 v12, s[32:35], s55 offen offset:2048 nt lds
    buffer_load_dwordx4 v13, s[32:35], s55 offen offset:3072 nt lds
    s_add_u32 s57, s57, 16384
    s_and_b32 s57, s57, 0x1ffff
    s_add_u32 m0, s53, 16384
    s_add_u32 s55, s58, 0
    buffer_load_dwordx4 v14, s[36:39], s55 offen offset:0 nt lds
    buffer_load_dwordx4 v14, s[36:39], s55 offen offset:1024 nt lds
    buffer_load_dwordx4 v14, s[36:39], s55 offen offset:2048 nt lds
    buffer_load_dwordx4 v14, s[36:39], s55 offen offset:3072 nt lds
    s_add_u32 m0, s53, 20480
    s_add_u32 s55, s58, 4096
    buffer_load_dwordx4 v14, s[36:39], s55 offen offset:0 nt lds
    buffer_load_dwordx4 v14, s[36:39], s55 offen offset:1024 nt lds
    buffer_load_dwordx4 v14, s[36:39], s55 offen offset:2048 nt lds
    buffer_load_dwordx4 v14, s[36:39], s55 offen offset:3072 nt lds
    s_add_u32 m0, s53, 24576
    s_add_u32 s55, s58, 8192
    buffer_load_dwordx4 v14, s[36:39], s55 offen offset:0 nt lds
    buffer_load_dwordx4 v14, s[36:39], s55 offen offset:1024 nt lds
    buffer_load_dwordx4 v14, s[36:39], s55 offen offset:2048 nt lds
    buffer_load_dwordx4 v14, s[36:39], s55 offen offset:3072 nt lds
    s_add_u32 m0, s53, 28672
    s_add_u32 s55, s58, 12288
    buffer_load_dwordx4 v14, s[36:39], s55 offen offset:0 nt lds
    buffer_load_dwordx4 v14, s[36:39], s55 offen offset:1024 nt lds
    buffer_load_dwordx4 v14, s[36:39], s55 offen offset:2048 nt lds
    buffer_load_dwordx4 v14, s[36:39], s55 offen offset:3072 nt lds
    s_add_u32 s58, s58, 16384
    s_and_b32 s58, s58, 0x1ffff
    s_add_u32 s53, s53, 32768
    s_cmp_eq_u32 s53, 163840
    s_cselect_b32 s53, 0, s53
    s_add_u32 s52, s52, 1
    s_waitcnt vmcnt(63)
    s_barrier
    s_add_u32 m0, s53, 0
    s_add_u32 s55, s57, 0
    buffer_load_dwordx4 v10, s[32:35], s55 offen offset:0 nt lds
    buffer_load_dwordx4 v11, s[32:35], s55 offen offset:1024 nt lds
    buffer_load_dwordx4 v12, s[32:35], s55 offen offset:2048 nt lds
    buffer_load_dwordx4 v13, s[32:35], s55 offen offset:3072 nt lds
    s_add_u32 m0, s53, 4096
    s_add_u32 s55, s57, 4096
    buffer_load_dwordx4 v10, s[32:35], s55 offen offset:0 nt lds
    buffer_load_dwordx4 v11, s[32:35], s55 offen offset:1024 nt lds
    buffer_load_dwordx4 v12, s[32:35], s55 offen offset:2048 nt lds
    buffer_load_dwordx4 v13, s[32:35], s55 offen offset:3072 nt lds
    s_add_u32 m0, s53, 8192
    s_add_u32 s55, s57, 8192
    buffer_load_dwordx4 v10, s[32:35], s55 offen offset:0 nt lds
    buffer_load_dwordx4 v11, s[32:35], s55 offen offset:1024 nt lds
    buffer_load_dwordx4 v12, s[32:35], s55 offen offset:2048 nt lds
    buffer_load_dwordx4 v13, s[32:35], s55 offen offset:3072 nt lds
    s_waitcnt vmcnt(60)
    s_barrier
    s_add_u32 m0, s53, 12288
    s_add_u32 s55, s57, 12288
    buffer_load_dwordx4 v10, s[32:35], s55 offen offset:0 nt lds
    buffer_load_dwordx4 v11, s[32:35], s55 offen offset:1024 nt lds
    buffer_load_dwordx4 v12, s[32:35], s55 offen offset:2048 nt lds
    buffer_load_dwordx4 v13, s[32:35], s55 offen offset:3072 nt lds
    s_add_u32 s57, s57, 16384
    s_and_b32 s57, s57, 0x1ffff
    s_add_u32 m0, s53, 16384
    s_add_u32 s55, s58, 0
    buffer_load_dwordx4 v14, s[36:39], s55 offen offset:0 nt lds
    buffer_load_dwordx4 v14, s[36:39], s55 offen offset:1024 nt lds
    buffer_load_dwordx4 v14, s[36:39], s55 offen offset:2048 nt lds
    buffer_load_dwordx4 v14, s[36:39], s55 offen offset:3072 nt lds
    s_add_u32 m0, s53, 20480
    s_add_u32 s55, s58, 4096
    buffer_load_dwordx4 v14, s[36:39], s55 offen offset:0 nt lds
    buffer_load_dwordx4 v14, s[36:39], s55 offen offset:1024 nt lds
    buffer_load_dwordx4 v14, s[36:39], s55 offen offset:2048 nt lds
    buffer_load_dwordx4 v14, s[36:39], s55 offen offset:3072 nt lds
    s_add_u32 m0, s53, 24576
    s_add_u32 s55, s58, 8192
    buffer_load_dwordx4 v14, s[36:39], s55 offen offset:0 nt lds
    buffer_load_dwordx4 v14, s[36:39], s55 offen offset:1024 nt lds
    buffer_load_dwordx4 v14, s[36:39], s55 offen offset:2048 nt lds
    buffer_load_dwordx4 v14, s[36:39], s55 offen offset:3072 nt lds
    s_add_u32 m0, s53, 28672
    s_add_u32 s55, s58, 12288
    buffer_load_dwordx4 v14, s[36:39], s55 offen offset:0 nt lds
    buffer_load_dwordx4 v14, s[36:39], s55 offen offset:1024 nt lds
    buffer_load_dwordx4 v14, s[36:39], s55 offen offset:2048 nt lds
    buffer_load_dwordx4 v14, s[36:39], s55 offen offset:3072 nt lds
    s_add_u32 s58, s58, 16384
    s_and_b32 s58, s58, 0x1ffff
    s_add_u32 s53, s53, 32768
    s_cmp_eq_u32 s53, 163840
    s_cselect_b32 s53, 0, s53
    s_add_u32 s52, s52, 1
    s_mul_i32 s55, s20, 589824
    s_mul_i32 s56, s22, 288
    s_add_u32 s55, s55, s56
    s_add_u32 s44, s12, s55
    s_addc_u32 s45, s13, 0
    s_sub_u32 s46, 4718592, s55
    s_mov_b32 s47, 0x00020000
    s_mov_b32 s48, s18
    s_mov_b32 s49, s19
    s_mov_b32 s50, 33554432
    s_mov_b32 s51, 0x00020000
    v_mov_b32 v44, 0
    v_mov_b32 v45, 0
    v_mov_b32 v46, 0
    v_mov_b32 v47, 0
    v_mov_b32 v48, 0
    v_mov_b32 v49, 0
    v_mov_b32 v50, 0
    v_mov_b32 v51, 0
    v_mov_b32 v52, 0
    v_mov_b32 v56, 0
    v_mov_b32 v57, 0
    v_mov_b32 v58, 0
    v_mov_b32 v63, 0
    s_mov_b32 s28, s16
    s_mov_b32 s29, s17
    s_mov_b32 s30, 256
    s_mov_b32 s31, 0x00020000
L_lk:
    s_waitcnt vmcnt(63)
L_lk_bar:
    s_barrier
    s_cmp_gt_u32 s52, 16
    s_cbranch_scc1 L_lk_v
    s_add_u32 m0, s53, 0
    s_add_u32 s55, s57, 0
    buffer_load_dwordx4 v10, s[32:35], s55 offen offset:0 nt lds
    buffer_load_dwordx4 v11, s[32:35], s55 offen offset:1024 nt lds
    buffer_load_dwordx4 v12, s[32:35], s55 offen offset:2048 nt lds
    buffer_load_dwordx4 v13, s[32:35], s55 offen offset:3072 nt lds
    s_add_u32 m0, s53, 4096
    s_add_u32 s55, s57, 4096
    buffer_load_dwordx4 v10, s[32:35], s55 offen offset:0 nt lds
    buffer_load_dwordx4 v11, s[32:35], s55 offen offset:1024 nt lds
    buffer_load_dwordx4 v12, s[32:35], s55 offen offset:2048 nt lds
    buffer_load_dwordx4 v13, s[32:35], s55 offen offset:3072 nt lds
    s_add_u32 m0, s53, 8192
    s_add_u32 s55, s57, 8192
    buffer_load_dwordx4 v10, s[32:35], s55 offen offset:0 nt lds
    buffer_load_dwordx4 v11, s[32:35], s55 offen offset:1024 nt lds
    buffer_load_dwordx4 v12, s[32:35], s55 offen offset:2048 nt lds
    buffer_load_dwordx4 v13, s[32:35], s55 offen offset:3072 nt lds
    s_add_u32 m0, s53, 12288
    s_add_u32 s55, s57, 12288
    buffer_load_dwordx4 v10, s[32:35], s55 offen offset:0 nt lds
    buffer_load_dwordx4 v11, s[32:35], s55 offen offset:1024 nt lds
    buffer_load_dwordx4 v12, s[32:35], s55 offen offset:2048 nt lds
    buffer_load_dwordx4 v13, s[32:35], s55 offen offset:3072 nt lds
    s_add_u32 s57, s57, 16384
    s_and_b32 s57, s57, 0x1ffff
L_lk_v:
    s_add_u32 m0, s53, 16384
    s_add_u32 s55, s58, 0
    buffer_load_dwordx4 v14, s[36:39], s55 offen offset:0 nt lds
    buffer_load_dwordx4 v14, s[36:39], s55 offen offset:1024 nt lds
    buffer_load_dwordx4 v14, s[36:39], s55 offen offset:2048 nt lds
    buffer_load_dwordx4 v14, s[36:39], s55 offen offset:3072 nt lds
    s_add_u32 m0, s53, 20480
    s_add_u32 s55, s58, 4096
    buffer_load_dwordx4 v14, s[36:39], s55 offen offset:0 nt lds
    buffer_load_dwordx4 v14, s[36:39], s55 offen offset:1024 nt lds
    buffer_load_dwordx4 v14, s[36:39], s55 offen offset:2048 nt lds
    buffer_load_dwordx4 v14, s[36:39], s55 offen offset:3072 nt lds
    s_add_u32 m0, s53, 24576
    s_add_u32 s55, s58, 8192
    buffer_load_dwordx4 v14, s[36:39], s55 offen offset:0 nt lds
    buffer_load_dwordx4 v14, s[36:39], s55 offen offset:1024 nt lds
    buffer_load_dwordx4 v14, s[36:39], s55 offen offset:2048 nt lds
    buffer_load_dwordx4 v14, s[36:39], s55 offen offset:3072 nt lds
    s_add_u32 m0, s53, 28672
    s_add_u32 s55, s58, 12288
    buffer_load_dwordx4 v14, s[36:39], s55 offen offset:0 nt lds
    buffer_load_dwordx4 v14, s[36:39], s55 offen offset:1024 nt lds
    buffer_load_dwordx4 v14, s[36:39], s55 offen offset:2048 nt lds
    buffer_load_dwordx4 v14, s[36:39], s55 offen offset:3072 nt lds
    s_add_u32 s58, s58, 16384
    s_and_b32 s58, s58, 0x1ffff
    s_cmp_lg_u32 s52, 13
    s_cbranch_scc1 L_lk_nowo0
    v_add_u32 v40, 0, v0
    v_mul_u32_u24 v41, 3641, v40
    v_lshrrev_b32 v41, 16, v41
    v_mul_u32_u24 v42, 18, v41
    v_sub_u32 v40, v40, v42
    v_cmp_gt_u32 vcc, 2, v40
    v_add_u32 v42, 16, v40
    v_lshl_add_u32 v40, s20, 1, v40
    v_and_b32 v40, 15, v40
    v_cndmask_b32 v40, v40, v42, vcc
    v_and_b32 v42, 3, v41
    v_bfe_u32 v43, v41, 2, 1
    v_lshl_or_b32 v42, v43, 4, v42
    v_lshrrev_b32 v43, 3, v41
    v_lshl_or_b32 v42, v43, 2, v42
    v_mul_u32_u24 v42, 1152, v42
    v_lshl_add_u32 v44, v40, 4, v42
    v_add_u32 v40, 64, v0
    v_mul_u32_u24 v41, 3641, v40
    v_lshrrev_b32 v41, 16, v41
    v_mul_u32_u24 v42, 18, v41
    v_sub_u32 v40, v40, v42
    v_cmp_gt_u32 vcc, 2, v40
    v_add_u32 v42, 16, v40
    v_lshl_add_u32 v40, s20, 1, v40
    v_and_b32 v40, 15, v40
    v_cndmask_b32 v40, v40, v42, vcc
    v_and_b32 v42, 3, v41
    v_bfe_u32 v43, v41, 2, 1
    v_lshl_or_b32 v42, v43, 4, v42
    v_lshrrev_b32 v43, 3, v41
    v_lshl_or_b32 v42, v43, 2, v42
    v_mul_u32_u24 v42, 1152, v42
    v_lshl_add_u32 v45, v40, 4, v42
    v_subrev_u32 v45, 1024, v45
    v_add_u32 v40, 128, v0
    v_mul_u32_u24 v41, 3641, v40
    v_lshrrev_b32 v41, 16, v41
    v_mul_u32_u24 v42, 18, v41
    v_sub_u32 v40, v40, v42
    v_cmp_gt_u32 vcc, 2, v40
    v_add_u32 v42, 16, v40
    v_lshl_add_u32 v40, s20, 1, v40
    v_and_b32 v40, 15, v40
    v_cndmask_b32 v40, v40, v42, vcc
    v_and_b32 v42, 3, v41
    v_bfe_u32 v43, v41, 2, 1
    v_lshl_or_b32 v42, v43, 4, v42
    v_lshrrev_b32 v43, 3, v41
    v_lshl_or_b32 v42, v43, 2, v42
    v_mul_u32_u24 v42, 1152, v42
    v_lshl_add_u32 v46, v40, 4, v42
    v_subrev_u32 v46, 2048, v46
    s_lshl2_add_u32 s55, s23, s22
    s_mul_i32 s55, s55, 18432
    s_mul_i32 s56, s22, 288
    s_sub_u32 s55, s55, s56
    v_lshlrev_b32 v56, 7, v0
    v_add_u32 v56, s55, v56
    v_add_u32 v57, 8192, v56
    v_add_u32 v58, 10240, v56
    s_branch L_lk_next
L_lk_nowo0:
    s_cmp_lg_u32 s52, 14
    s_cbranch_scc1 L_lk_nowo1
    v_add_u32 v40, 192, v0
    v_mul_u32_u24 v41, 3641, v40
    v_lshrrev_b32 v41, 16, v41
    v_mul_u32_u24 v42, 18, v41
    v_sub_u32 v40, v40, v42
    v_cmp_gt_u32 vcc, 2, v40
    v_add_u32 v42, 16, v40
    v_lshl_add_u32 v40, s20, 1, v40
    v_and_b32 v40, 15, v40
    v_cndmask_b32 v40, v40, v42, vcc
    v_and_b32 v42, 3, v41
    v_bfe_u32 v43, v41, 2, 1
    v_lshl_or_b32 v42, v43, 4, v42
    v_lshrrev_b32 v43, 3, v41
    v_lshl_or_b32 v42, v43, 2, v42
    v_mul_u32_u24 v42, 1152, v42
    v_lshl_add_u32 v47, v40, 4, v42
    v_subrev_u32 v47, 3072, v47
    v_add_u32 v40, 256, v0
    v_mul_u32_u24 v41, 3641, v40
    v_lshrrev_b32 v41, 16, v41
    v_mul_u32_u24 v42, 18, v41
    v_sub_u32 v40, v40, v42
    v_cmp_gt_u32 vcc, 2, v40
    v_add_u32 v42, 16, v40
    v_lshl_add_u32 v40, s20, 1, v40
    v_and_b32 v40, 15, v40
    v_cndmask_b32 v40, v40, v42, vcc
    v_and_b32 v42, 3, v41
    v_bfe_u32 v43, v41, 2, 1
    v_lshl_or_b32 v42, v43, 4, v42
    v_lshrrev_b32 v43, 3, v41
    v_lshl_or_b32 v42, v43, 2, v42
    v_mul_u32_u24 v42, 1152, v42
    v_lshl_add_u32 v48, v40, 4, v42
    v_add_u32 v40, 320, v0
    v_mul_u32_u24 v41, 3641, v40
    v_lshrrev_b32 v41, 16, v41
    v_mul_u32_u24 v42, 18, v41
    v_sub_u32 v40, v40, v42
    v_cmp_gt_u32 vcc, 2, v40
    v_add_u32 v42, 16, v40
    v_lshl_add_u32 v40, s20, 1, v40
    v_and_b32 v40, 15, v40
    v_cndmask_b32 v40, v40, v42, vcc
    v_and_b32 v42, 3, v41
    v_bfe_u32 v43, v41, 2, 1
    v_lshl_or_b32 v42, v43, 4, v42
    v_lshrrev_b32 v43, 3, v41
    v_lshl_or_b32 v42, v43, 2, v42
    v_mul_u32_u24 v42, 1152, v42
    v_lshl_add_u32 v49, v40, 4, v42
    v_subrev_u32 v49, 1024, v49
    s_branch L_lk_next
L_lk_nowo1:
    s_cmp_lg_u32 s52, 15
    s_cbranch_scc1 L_lk_nowo2
    v_add_u32 v40, 384, v0
    v_mul_u32_u24 v41, 3641, v40
    v_lshrrev_b32 v41, 16, v41
    v_mul_u32_u24 v42, 18, v41
    v_sub_u32 v40, v40, v42
    v_cmp_gt_u32 vcc, 2, v40
    v_add_u32 v42, 16, v40
    v_lshl_add_u32 v40, s20, 1, v40
    v_and_b32 v40, 15, v40
    v_cndmask_b32 v40, v40, v42, vcc
    v_and_b32 v42, 3, v41
    v_bfe_u32 v43, v41, 2, 1
    v_lshl_or_b32 v42, v43, 4, v42
    v_lshrrev_b32 v43, 3, v41
    v_lshl_or_b32 v42, v43, 2, v42
    v_mul_u32_u24 v42, 1152, v42
    v_lshl_add_u32 v50, v40, 4, v42
    v_subrev_u32 v50, 2048, v50
    v_add_u32 v40, 448, v0
    v_mul_u32_u24 v41, 3641, v40
    v_lshrrev_b32 v41, 16, v41
    v_mul_u32_u24 v42, 18, v41
    v_sub_u32 v40, v40, v42
    v_cmp_gt_u32 vcc, 2, v40
    v_add_u32 v42, 16, v40
    v_lshl_add_u32 v40, s20, 1, v40
    v_and_b32 v40, 15, v40
    v_cndmask_b32 v40, v40, v42, vcc
    v_and_b32 v42, 3, v41
    v_bfe_u32 v43, v41, 2, 1
    v_lshl_or_b32 v42, v43, 4, v42
    v_lshrrev_b32 v43, 3, v41
    v_lshl_or_b32 v42, v43, 2, v42
    v_mul_u32_u24 v42, 1152, v42
    v_lshl_add_u32 v51, v40, 4, v42
    v_subrev_u32 v51, 3072, v51
    v_add_u32 v40, 512, v0
    v_mul_u32_u24 v41, 3641, v40
    v_lshrrev_b32 v41, 16, v41
    v_mul_u32_u24 v42, 18, v41
    v_sub_u32 v40, v40, v42
    v_cmp_gt_u32 vcc, 2, v40
    v_add_u32 v42, 16, v40
    v_lshl_add_u32 v40, s20, 1, v40
    v_and_b32 v40, 15, v40
    v_cndmask_b32 v40, v40, v42, vcc
    v_and_b32 v42, 3, v41
    v_bfe_u32 v43, v41, 2, 1
    v_lshl_or_b32 v42, v43, 4, v42
    v_lshrrev_b32 v43, 3, v41
    v_lshl_or_b32 v42, v43, 2, v42
    v_mul_u32_u24 v42, 1152, v42
    v_lshl_add_u32 v52, v40, 4, v42
    s_branch L_lk_next
L_lk_nowo2:
    s_cmp_lg_u32 s52, 17
    s_cbranch_scc1 L_lk_next
    buffer_load_dword v60, v56, s[44:47], 0 offen
    buffer_load_dword v61, v57, s[44:47], 0 offen
    buffer_load_dword v62, v58, s[44:47], 0 offen
L_lk_next:
    s_add_u32 s53, s53, 32768
    s_cmp_eq_u32 s53, 163840
    s_cselect_b32 s53, 0, s53
    s_add_u32 s52, s52, 1
    s_cmp_lt_u32 s52, 18
    s_cbranch_scc1 L_lk
    s_lshl_b32 s54, s22, 2
    s_mov_b32 s59, 98304
    s_waitcnt vmcnt(51)
    s_barrier
    s_lshl_b32 s57, s23, 5
    v_mov_b32 v59, 1
    s_mov_b64 exec, 1
    buffer_atomic_add v59, off, s[28:31], s57 sc1
    s_mov_b64 exec, -1
    s_mov_b32 s52, 2
L_lw1:
    s_mul_i32 s55, s54, 36864
    s_add_u32 m0, s59, 0
    s_nop 0
    buffer_load_dwordx4 v44, s[44:47], s55 offen offset:0 lds
    buffer_load_dwordx4 v45, s[44:47], s55 offen offset:1024 lds
    buffer_load_dwordx4 v46, s[44:47], s55 offen offset:2048 lds
    buffer_load_dwordx4 v47, s[44:47], s55 offen offset:3072 lds
    s_add_u32 m0, s59, 4096
    s_nop 0
    buffer_load_dwordx4 v48, s[44:47], s55 offen offset:0 lds
    buffer_load_dwordx4 v49, s[44:47], s55 offen offset:1024 lds
    buffer_load_dwordx4 v50, s[44:47], s55 offen offset:2048 lds
    buffer_load_dwordx4 v51, s[44:47], s55 offen offset:3072 lds
    s_add_u32 m0, s59, 8192
    s_nop 0
    buffer_load_dwordx4 v52, s[44:47], s55 offen offset:0 lds
    s_add_u32 s54, s54, 1
    s_and_b32 s54, s54, 15
    s_add_u32 s59, s59, 9216
    s_cmp_eq_u32 s59, 162816
    s_cselect_b32 s59, 0, s59
    s_sub_u32 s52, s52, 1
    s_cmp_lg_u32 s52, 0
    s_cbranch_scc1 L_lw1
    s_waitcnt vmcnt(38)
    s_barrier
    s_mov_b32 s52, 7
L_lw2:
    s_mul_i32 s55, s54, 36864
    s_add_u32 m0, s59, 0
    s_nop 0
    buffer_load_dwordx4 v44, s[44:47], s55 offen offset:0 lds
    buffer_load_dwordx4 v45, s[44:47], s55 offen offset:1024 lds
    buffer_load_dwordx4 v46, s[44:47], s55 offen offset:2048 lds
    buffer_load_dwordx4 v47, s[44:47], s55 offen offset:3072 lds
    s_add_u32 m0, s59, 4096
    s_nop 0
    buffer_load_dwordx4 v48, s[44:47], s55 offen offset:0 lds
    buffer_load_dwordx4 v49, s[44:47], s55 offen offset:1024 lds
    buffer_load_dwordx4 v50, s[44:47], s55 offen offset:2048 lds
    buffer_load_dwordx4 v51, s[44:47], s55 offen offset:3072 lds
    s_add_u32 m0, s59, 8192
    s_nop 0
    buffer_load_dwordx4 v52, s[44:47], s55 offen offset:0 lds
    s_add_u32 s54, s54, 1
    s_and_b32 s54, s54, 15
    s_add_u32 s59, s59, 9216
    s_cmp_eq_u32 s59, 162816
    s_cselect_b32 s59, 0, s59
    s_sub_u32 s52, s52, 1
    s_cmp_lg_u32 s52, 0
    s_cbranch_scc1 L_lw2
    s_waitcnt vmcnt(63)
    s_barrier
    s_mov_b32 s52, 5
L_lw3:
    s_mul_i32 s55, s54, 36864
    s_add_u32 m0, s59, 0
    s_nop 0
    buffer_load_dwordx4 v44, s[44:47], s55 offen offset:0 lds
    buffer_load_dwordx4 v45, s[44:47], s55 offen offset:1024 lds
    buffer_load_dwordx4 v46, s[44:47], s55 offen offset:2048 lds
    buffer_load_dwordx4 v47, s[44:47], s55 offen offset:3072 lds
    s_add_u32 m0, s59, 4096
    s_nop 0
    buffer_load_dwordx4 v48, s[44:47], s55 offen offset:0 lds
    buffer_load_dwordx4 v49, s[44:47], s55 offen offset:1024 lds
    buffer_load_dwordx4 v50, s[44:47], s55 offen offset:2048 lds
    buffer_load_dwordx4 v51, s[44:47], s55 offen offset:3072 lds
    s_add_u32 m0, s59, 8192
    s_nop 0
    buffer_load_dwordx4 v52, s[44:47], s55 offen offset:0 lds
    s_add_u32 s54, s54, 1
    s_and_b32 s54, s54, 15
    s_add_u32 s59, s59, 9216
    s_cmp_eq_u32 s59, 162816
    s_cselect_b32 s59, 0, s59
    s_sub_u32 s52, s52, 1
    s_cmp_lg_u32 s52, 0
    s_cbranch_scc1 L_lw3
    s_waitcnt vmcnt(63)
    s_barrier
    buffer_load_dword v63, off, s[28:31], s57 sc1
    s_mov_b32 s52, 2
L_lw4:
    s_mul_i32 s55, s54, 36864
    s_add_u32 m0, s59, 0
    s_nop 0
    buffer_load_dwordx4 v44, s[44:47], s55 offen offset:0 lds
    buffer_load_dwordx4 v45, s[44:47], s55 offen offset:1024 lds
    buffer_load_dwordx4 v46, s[44:47], s55 offen offset:2048 lds
    buffer_load_dwordx4 v47, s[44:47], s55 offen offset:3072 lds
    s_add_u32 m0, s59, 4096
    s_nop 0
    buffer_load_dwordx4 v48, s[44:47], s55 offen offset:0 lds
    buffer_load_dwordx4 v49, s[44:47], s55 offen offset:1024 lds
    buffer_load_dwordx4 v50, s[44:47], s55 offen offset:2048 lds
    buffer_load_dwordx4 v51, s[44:47], s55 offen offset:3072 lds
    s_add_u32 m0, s59, 8192
    s_nop 0
    buffer_load_dwordx4 v52, s[44:47], s55 offen offset:0 lds
    s_add_u32 s54, s54, 1
    s_and_b32 s54, s54, 15
    s_add_u32 s59, s59, 9216
    s_cmp_eq_u32 s59, 162816
    s_cselect_b32 s59, 0, s59
    s_sub_u32 s52, s52, 1
    s_cmp_lg_u32 s52, 0
    s_cbranch_scc1 L_lw4
    s_lshl3_add_u32 s76, s23, s20
    s_mul_i32 s76, s76, 1536
    s_add_u32 s76, s76, 25165824
    s_lshl2_add_u32 s77, s23, s22
    s_mul_i32 s77, s77, 3072
    s_add_u32 s77, s77, 25264128
    s_mul_i32 s55, s20, 384
    s_add_u32 s77, s77, s55
    v_lshrrev_b32 v40, 2, v0
    v_and_b32 v42, 3, v0
    v_mul_u32_u24 v41, 384, v40
    v_mul_u32_u24 v40, 4, v40
    v_lshl_add_u32 v41, v42, 7, v41
    v_lshl_add_u32 v40, v42, 7, v40
    s_waitcnt vmcnt(0)
    s_lshl_b32 s57, s23, 5
    v_cmp_gt_u32 vcc, 32, v63
    s_nop 2
    s_cbranch_vccz L_out_i
    s_mov_b32 s60, 0
L_poll_i:
    buffer_load_dword v63, off, s[28:31], s57 sc1
    s_add_u32 s60, s60, 1
    s_waitcnt vmcnt(0)
    v_cmp_gt_u32 vcc, 32, v63
    s_cmp_gt_u32 s60, 40000
    s_cbranch_scc1 L_out_i
    s_nop 1
    s_cbranch_vccnz L_poll_i
L_out_i:
    s_barrier
    s_endpgm
L_compute:
    s_sub_u32 s25, s25, 1
    v_and_b32 v18, 31, v0
    v_lshrrev_b32 v19, 5, v0
    v_bfe_u32 v20, v0, 1, 3
    v_xor_b32 v20, v20, v19
    v_lshlrev_b32 v20, 4, v20
    v_lshl_add_u32 v14, v18, 7, v20
    s_lshl_b32 s55, s25, 12
    v_add_u32 v14, s55, v14
    v_and_b32 v20, 15, v0
    v_xor_b32 v20, v20, v19
    v_lshlrev_b32 v20, 4, v20
    v_lshl_add_u32 v16, v18, 8, v20
    v_bfe_u32 v18, v0, 2, 2
    v_mul_u32_u24 v18, 320, v18
    v_bfe_u32 v20, v0, 4, 1
    v_lshl_add_u32 v18, v20, 5, v18
    v_and_b32 v20, 3, v0
    v_lshl_add_u32 v17, v20, 3, v18
    v_lshl_add_u32 v17, v19, 10, v17
    v_and_b32 v20, 1, v0
    v_lshl_add_u32 v15, v20, 4, v18
    v_bfe_u32 v20, v0, 1, 1
    v_lshl_add_u32 v15, v20, 3, v15
    v_lshl_add_u32 v15, v19, 11, v15
    v_lshrrev_b32 v18, 2, v0
    v_xor_b32 v18, v18, v0
    v_bfe_u32 v18, v18, 2, 1
    v_add_u32 v18, -1, v18
    v_and_b32 v18, 0x3f803f80, v18
    v_accvgpr_write_b32 a132, v18
    v_mov_b32 v22, 0
    v_accvgpr_write_b32 a133, v18
    v_mov_b32 v23, 0
    v_accvgpr_write_b32 a134, v18
    v_mov_b32 v24, 0
    v_accvgpr_write_b32 a135, v18
    v_mov_b32 v25, 0
    v_accvgpr_write_b32 a32, 0
    v_accvgpr_write_b32 a33, 0
    v_accvgpr_write_b32 a34, 0
    v_accvgpr_write_b32 a35, 0
    v_accvgpr_write_b32 a36, 0
    v_accvgpr_write_b32 a37, 0
    v_accvgpr_write_b32 a38, 0
    v_accvgpr_write_b32 a39, 0
    v_accvgpr_write_b32 a40, 0
    v_accvgpr_write_b32 a41, 0
    v_accvgpr_write_b32 a42, 0
    v_accvgpr_write_b32 a43, 0
    v_accvgpr_write_b32 a44, 0
    v_accvgpr_write_b32 a45, 0
    v_accvgpr_write_b32 a46, 0
    v_accvgpr_write_b32 a47, 0
    v_accvgpr_write_b32 a48, 0
    v_accvgpr_write_b32 a49, 0
    v_accvgpr_write_b32 a50, 0
    v_accvgpr_write_b32 a51, 0
    v_accvgpr_write_b32 a52, 0
    v_accvgpr_write_b32 a53, 0
    v_accvgpr_write_b32 a54, 0
    v_accvgpr_write_b32 a55, 0
    v_accvgpr_write_b32 a56, 0
    v_accvgpr_write_b32 a57, 0
    v_accvgpr_write_b32 a58, 0
    v_accvgpr_write_b32 a59, 0
    v_accvgpr_write_b32 a60, 0
    v_accvgpr_write_b32 a61, 0
    v_accvgpr_write_b32 a62, 0
    v_accvgpr_write_b32 a63, 0
    v_accvgpr_write_b32 a72, 0
    v_accvgpr_write_b32 a73, 0
    v_accvgpr_write_b32 a74, 0
    v_accvgpr_write_b32 a75, 0
    v_accvgpr_write_b32 a76, 0
    v_accvgpr_write_b32 a77, 0
    v_accvgpr_write_b32 a78, 0
    v_accvgpr_write_b32 a79, 0
    v_mfma_f32_32x32x16_bf16 v[192:207], a[32:35], a[32:35], 0
    v_mfma_f32_32x32x16_bf16 v[208:223], a[32:35], a[32:35], 0
    v_mfma_f32_32x32x16_bf16 v[224:239], a[32:35], a[32:35], 0
    v_mfma_f32_32x32x16_bf16 v[240:255], a[32:35], a[32:35], 0
    v_mfma_f32_32x32x16_bf16 v[128:143], a[32:35], a[32:35], 0
    v_mfma_f32_32x32x16_bf16 v[144:159], a[32:35], a[32:35], 0
    v_mfma_f32_32x32x16_bf16 v[160:175], a[32:35], a[32:35], 0
    v_mfma_f32_32x32x16_bf16 v[176:191], a[32:35], a[32:35], 0
    s_mov_b32 s53, 0
    s_mov_b32 s60, 0
    s_mov_b32 s61, 0x3e0293ee
    s_mov_b32 s63, 0x40004000
    s_mul_i32 s77, s23, 2124800
    s_mul_i32 s78, s22, 3
    s_add_u32 s78, s78, s25
    s_mul_i32 s78, s78, 73728
    s_add_u32 s78, s78, s77
    s_add_u32 s78, s78, 1048576
    s_mul_i32 s79, s20, 9216
    s_add_u32 s79, s79, s78
    s_add_u32 s56, s22, 0
    s_and_b32 s56, s56, 3
    s_lshl2_add_u32 s56, s20, s56
    s_mul_i32 s56, s56, 3
    s_add_u32 s56, s56, s25
    s_mul_i32 s56, s56, 9216
    s_add_u32 s68, s56, s77
    s_add_u32 s69, s68, 4096
    s_add_u32 s56, s22, 1
    s_and_b32 s56, s56, 3
    s_lshl2_add_u32 s56, s20, s56
    s_mul_i32 s56, s56, 3
    s_add_u32 s56, s56, s25
    s_mul_i32 s56, s56, 9216
    s_add_u32 s70, s56, s77
    s_add_u32 s71, s70, 4096
    s_add_u32 s56, s22, 2
    s_and_b32 s56, s56, 3
    s_lshl2_add_u32 s56, s20, s56
    s_mul_i32 s56, s56, 3
    s_add_u32 s56, s56, s25
    s_mul_i32 s56, s56, 9216
    s_add_u32 s72, s56, s77
    s_add_u32 s73, s72, 4096
    s_add_u32 s56, s22, 3
    s_and_b32 s56, s56, 3
    s_lshl2_add_u32 s56, s20, s56
    s_mul_i32 s56, s56, 3
    s_add_u32 s56, s56, s25
    s_mul_i32 s56, s56, 9216
    s_add_u32 s74, s56, s77
    s_add_u32 s75, s74, 4096
    v_lshlrev_b32 v1, 4, v0
    s_lshl3_add_u32 s76, s23, s20
    s_mul_i32 s76, s76, 1536
    s_add_u32 s76, s76, 25165824
    s_lshl2_add_u32 s77, s23, s22
    s_mul_i32 s77, s77, 3072
    s_add_u32 s77, s77, 25264128
    s_mul_i32 s42, s22, 0
    s_add_u32 s42, s42, s76
    s_mul_i32 s43, s20, 384
    s_add_u32 s43, s43, s77
    s_mul_i32 s55, s22, 384
    s_add_u32 s76, s76, s55
    s_mul_i32 s55, s20, 4
    s_add_u32 s77, s77, s55
    v_lshrrev_b32 v21, 2, v0
    v_mul_u32_u24 v28, 196608, v21
    v_add_u32 v28, s76, v28
    v_subrev_u32 v21, 4, v21
    v_and_b32 v21, 7, v21
    v_mul_u32_u24 v29, 4, v21
    v_add_u32 v29, s43, v29
    v_cmp_gt_u32 vcc, 16, v0
    v_and_b32 v21, 3, v0
    s_nop 0
    v_cndmask_b32 v28, v29, v28, vcc
    v_lshl_add_u32 v21, v21, 7, v28
    v_mov_b32 v28, 0
    s_lshl_b32 s55, s25, 7
    s_add_u32 s76, s76, s55
    s_add_u32 s77, s77, s55
    s_add_u32 s42, s42, s55
    s_add_u32 s43, s43, s55
    s_lshl_b32 s55, 1, s22
    s_andn2_b32 s44, 15, s55
    s_mov_b32 s45, 0
    s_lshl_b32 s55, 1, s20
    s_andn2_b32 s46, 0xff, s55
    s_mov_b32 s47, 0
    s_waitcnt lgkmcnt(0)
    s_mov_b32 s48, s18
    s_mov_b32 s49, s19
    s_mov_b32 s50, 33554432
    s_mov_b32 s51, 0x00020000
    s_mov_b32 s28, s16
    s_mov_b32 s29, s17
    s_mov_b32 s30, 256
    s_mov_b32 s31, 0x00020000
    s_mov_b32 s32, s14
    s_mov_b32 s33, s15
    s_mov_b32 s34, 884736
    s_mov_b32 s35, 0x00020000
    s_add_u32 s36, s18, s79
    s_addc_u32 s37, s19, 0
    s_mov_b32 s38, 8192
    s_mov_b32 s39, 0x00020000
    s_lshl_b32 s56, s20, 3
    v_and_b32 v64, 7, v0
    v_add_u32 v64, s56, v64
    v_lshrrev_b32 v68, 3, v0
    v_mul_u32_u24 v68, 9216, v68
    v_lshl_add_u32 v68, v64, 4, v68
    v_and_b32 v66, 15, v0
    v_mul_u32_u24 v66, 1152, v66
    v_lshrrev_b32 v65, 4, v0
    v_lshl_add_u32 v66, v65, 3, v66
    s_lshl_b32 s56, s20, 5
    v_add_u32 v66, s56, v66
    v_and_b32 v67, 15, v64
    v_lshrrev_b32 v65, 5, v0
    v_lshl_add_u32 v67, v65, 4, v67
    v_mul_u32_u24 v67, 1152, v67
    v_lshrrev_b32 v64, 4, v64
    v_lshl_add_u32 v67, v64, 3, v67
    v_bfe_u32 v65, v0, 4, 1
    v_lshl_add_u32 v67, v65, 2, v67
    v_accvgpr_write_b32 a142, v66
    v_accvgpr_write_b32 a143, v67
    v_accvgpr_write_b32 a144, v68
    s_sub_u32 s56, s20, 1
    s_and_b32 s56, s56, 7
    s_mul_i32 s56, s56, 9216
    s_add_u32 s56, s56, s78
    s_add_u32 s81, s56, 1024
    s_sub_u32 s56, s20, 2
    s_and_b32 s56, s56, 7
    s_mul_i32 s56, s56, 9216
    s_add_u32 s56, s56, s78
    s_add_u32 s82, s56, 2048
    s_sub_u32 s56, s20, 3
    s_and_b32 s56, s56, 7
    s_mul_i32 s56, s56, 9216
    s_add_u32 s56, s56, s78
    s_add_u32 s83, s56, 3072
    s_sub_u32 s56, s20, 4
    s_and_b32 s56, s56, 7
    s_mul_i32 s56, s56, 9216
    s_add_u32 s56, s56, s78
    s_add_u32 s84, s56, 4096
    s_sub_u32 s56, s20, 5
    s_and_b32 s56, s56, 7
    s_mul_i32 s56, s56, 9216
    s_add_u32 s56, s56, s78
    s_add_u32 s85, s56, 5120
    s_sub_u32 s56, s20, 6
    s_and_b32 s56, s56, 7
    s_mul_i32 s56, s56, 9216
    s_add_u32 s56, s56, s78
    s_add_u32 s86, s56, 6144
    s_sub_u32 s56, s20, 7
    s_and_b32 s56, s56, 7
    s_mul_i32 s56, s56, 9216
    s_add_u32 s56, s56, s78
    s_add_u32 s87, s56, 7168
    s_mul_i32 s54, s23, 3
    s_add_u32 s54, s54, s25
    s_mul_i32 s54, s54, 36864
    s_mul_i32 s52, s22, 288
    s_add_u32 s54, s54, s52
    s_add_u32 s52, s54, 18432
    s_add_u32 s40, s76, 196608
    v_lshrrev_b32 v64, 4, v0
    v_bfe_u32 v65, v0, 2, 2
    v_xor_b32 v64, v64, v65
    v_bfe_u32 v65, v0, 1, 1
    v_lshl_or_b32 v64, v64, 1, v65
    v_and_b32 v65, 1, v0
    v_lshlrev_b32 v65, 4, v65
    v_mov_b32 v66, 0x3f80
    v_lshlrev_b32 v65, v65, v66
    v_cmp_eq_u32 vcc, 0, v64
    s_nop 1
    v_cndmask_b32 v66, 0, v65, vcc
    v_cmp_eq_u32 vcc, 1, v64
    s_nop 1
    v_cndmask_b32 v67, 0, v65, vcc
    v_accvgpr_write_b32 a138, v66
    v_accvgpr_write_b32 a139, v67
    v_accvgpr_write_b32 a136, 0
    v_accvgpr_write_b32 a137, 0
    v_accvgpr_write_b32 a140, 0
    v_accvgpr_write_b32 a141, 0
    v_add_u32 v2, s53, v14
    v_xor_b32 v3, 32, v2
    v_xor_b32 v4, 64, v2
    v_xor_b32 v5, 96, v2
    v_add_u32 v10, s53, v15
    v_xor_b32 v11, 64, v10
    v_xor_b32 v12, 128, v10
    v_xor_b32 v13, 192, v10
.p2align 3
L_xw:
    s_barrier
    ds_read_b128 a[64:67], v2
    ds_read_b64_tr_b16 a[0:1], v10 offset:12288
    ds_read_b64_tr_b16 a[2:3], v10 offset:13312
    v_mfma_f32_32x32x16_bf16 v[192:207], a[32:35], a[72:75], v[192:207]
    ds_read_b64_tr_b16 a[4:5], v11 offset:12288
    ds_read_b64_tr_b16 a[6:7], v11 offset:13312
    ds_read_b64_tr_b16 a[8:9], v12 offset:12288
    v_mfma_f32_32x32x16_bf16 v[208:223], a[36:39], a[72:75], v[208:223]
    ds_read_b64_tr_b16 a[10:11], v12 offset:13312
    ds_read_b64_tr_b16 a[12:13], v13 offset:12288
    ds_read_b64_tr_b16 a[14:15], v13 offset:13312
    v_mfma_f32_32x32x16_bf16 v[224:239], a[40:43], a[72:75], v[224:239]
    ds_read_b128 a[68:71], v3
    ds_read_b64_tr_b16 a[16:17], v10 offset:16384
    ds_read_b64_tr_b16 a[18:19], v10 offset:17408
    v_mfma_f32_32x32x16_bf16 v[240:255], a[44:47], a[72:75], v[240:255]
    ds_read_b64_tr_b16 a[20:21], v11 offset:16384
    ds_read_b64_tr_b16 a[22:23], v11 offset:17408
    ds_read_b64_tr_b16 a[24:25], v12 offset:16384
    v_mfma_f32_32x32x16_bf16 v[192:207], a[48:51], a[76:79], v[192:207]
    ds_read_b64_tr_b16 a[26:27], v12 offset:17408
    ds_read_b64_tr_b16 a[28:29], v13 offset:16384
    ds_read_b64_tr_b16 a[30:31], v13 offset:17408
    v_mfma_f32_32x32x16_bf16 v[208:223], a[52:55], a[76:79], v[208:223]
    ds_read_b128 a[72:75], v4
    ds_read_b64_tr_b16 a[32:33], v10 offset:20480
    ds_read_b64_tr_b16 a[34:35], v10 offset:21504
    v_mfma_f32_32x32x16_bf16 v[224:239], a[56:59], a[76:79], v[224:239]
    ds_read_b64_tr_b16 a[36:37], v11 offset:20480
    ds_read_b64_tr_b16 a[38:39], v11 offset:21504
    ds_read_b64_tr_b16 a[40:41], v12 offset:20480
    v_mfma_f32_32x32x16_bf16 v[240:255], a[60:63], a[76:79], v[240:255]
    ds_read_b64_tr_b16 a[42:43], v12 offset:21504
    ds_read_b64_tr_b16 a[44:45], v13 offset:20480
    ds_read_b64_tr_b16 a[46:47], v13 offset:21504
    s_waitcnt lgkmcnt(9)
    v_mfma_f32_32x32x16_bf16 v[192:207], a[0:3], a[64:67], v[192:207]
    ds_read_b128 a[76:79], v5
    ds_read_b64_tr_b16 a[48:49], v10 offset:24576
    ds_read_b64_tr_b16 a[50:51], v10 offset:25600
    v_mfma_f32_32x32x16_bf16 v[208:223], a[4:7], a[64:67], v[208:223]
    ds_read_b64_tr_b16 a[52:53], v11 offset:24576
    ds_read_b64_tr_b16 a[54:55], v11 offset:25600
    ds_read_b64_tr_b16 a[56:57], v12 offset:24576
    v_mfma_f32_32x32x16_bf16 v[224:239], a[8:11], a[64:67], v[224:239]
    ds_read_b64_tr_b16 a[58:59], v12 offset:25600
    ds_read_b64_tr_b16 a[60:61], v13 offset:24576
    ds_read_b64_tr_b16 a[62:63], v13 offset:25600
    v_mfma_f32_32x32x16_bf16 v[240:255], a[12:15], a[64:67], v[240:255]
    s_add_u32 s53, s53, 32768
    s_cmp_eq_u32 s53, 163840
    s_cselect_b32 s53, 0, s53
    v_add_u32 v2, s53, v14
    v_mfma_f32_32x32x16_bf16 v[192:207], a[16:19], a[68:71], v[192:207]
    s_cmp_lg_u32 s60, 1
    s_cbranch_scc1 L_xw_skip
    s_cmp_lg_u32 s25, 0
    s_cbranch_scc1 L_xw_skip
    s_mov_b32 exec_lo, 119
    s_mov_b32 exec_hi, 0
    buffer_store_dword v28, v21, s[48:51], 0 offen sc1
    s_mov_b64 exec, -1
L_xw_skip:
    v_xor_b32 v3, 32, v2
    v_xor_b32 v4, 64, v2
    v_xor_b32 v5, 96, v2
    v_add_u32 v10, s53, v15
    v_mfma_f32_32x32x16_bf16 v[208:223], a[20:23], a[68:71], v[208:223]
    v_xor_b32 v11, 64, v10
    v_xor_b32 v12, 128, v10
    v_xor_b32 v13, 192, v10
    s_add_u32 s60, s60, 1
    v_mfma_f32_32x32x16_bf16 v[224:239], a[24:27], a[68:71], v[224:239]
    s_cmp_lt_u32 s60, 9
    v_mfma_f32_32x32x16_bf16 v[240:255], a[28:31], a[68:71], v[240:255]
    s_waitcnt lgkmcnt(0)
    s_cbranch_scc1 L_xw
    v_add_u32 v2, s53, v16
    v_xor_b32 v3, 32, v2
    v_xor_b32 v4, 64, v2
    v_xor_b32 v5, 96, v2
    v_xor_b32 v6, 128, v2
    v_xor_b32 v7, 160, v2
    v_xor_b32 v8, 192, v2
    v_xor_b32 v9, 224, v2
    s_barrier
    ds_read_b128 a[0:3], v2 offset:0
    ds_read_b128 a[4:7], v3 offset:0
    v_mfma_f32_32x32x16_bf16 v[192:207], a[32:35], a[72:75], v[192:207]
    ds_read_b128 a[8:11], v4 offset:0
    ds_read_b128 a[12:15], v5 offset:0
    v_mfma_f32_32x32x16_bf16 v[192:207], a[48:51], a[76:79], v[192:207]
    ds_read_b128 a[16:19], v6 offset:0
    ds_read_b128 a[20:23], v7 offset:0
    v_mfma_f32_32x32x16_bf16 v[208:223], a[36:39], a[72:75], v[208:223]
    ds_read_b128 a[24:27], v8 offset:0
    ds_read_b128 a[28:31], v9 offset:0
    v_mfma_f32_32x32x16_bf16 v[208:223], a[52:55], a[76:79], v[208:223]
    s_nop 5
    v_mul_f32 v192, s61, v192
    v_mul_f32 v193, s61, v193
    v_mul_f32 v194, s61, v194
    v_mul_f32 v195, s61, v195
    v_mul_f32 v196, s61, v196
    v_mul_f32 v197, s61, v197
    v_mfma_f32_32x32x16_bf16 v[224:239], a[40:43], a[72:75], v[224:239]
    v_mul_f32 v198, s61, v198
    v_mul_f32 v199, s61, v199
    v_cvt_pk_bf16_f32 v32, v192, v193
    v_cvt_pk_bf16_f32 v33, v194, v195
    v_cvt_pk_bf16_f32 v34, v196, v197
    v_cvt_pk_bf16_f32 v35, v198, v199
    v_mfma_f32_32x32x16_bf16 v[224:239], a[56:59], a[76:79], v[224:239]
    v_mul_f32 v200, s61, v200
    v_mul_f32 v201, s61, v201
    v_mul_f32 v202, s61, v202
    v_mul_f32 v203, s61, v203
    v_mul_f32 v204, s61, v204
    v_mul_f32 v205, s61, v205
    v_mfma_f32_32x32x16_bf16 v[240:255], a[44:47], a[72:75], v[240:255]
    v_mul_f32 v206, s61, v206
    v_mul_f32 v207, s61, v207
    v_cvt_pk_bf16_f32 v36, v200, v201
    v_cvt_pk_bf16_f32 v37, v202, v203
    v_cvt_pk_bf16_f32 v38, v204, v205
    v_cvt_pk_bf16_f32 v39, v206, v207
    v_mfma_f32_32x32x16_bf16 v[240:255], a[60:63], a[76:79], v[240:255]
    v_mul_f32 v208, s61, v208
    v_mul_f32 v209, s61, v209
    v_mul_f32 v210, s61, v210
    v_mul_f32 v211, s61, v211
    v_mul_f32 v212, s61, v212
    v_mul_f32 v213, s61, v213
    v_mul_f32 v214, s61, v214
    v_mul_f32 v215, s61, v215
    s_waitcnt lgkmcnt(0)
    v_mfma_f32_32x32x16_bf16 v[64:79], a[0:3], v[32:35], 0
    v_cvt_pk_bf16_f32 v40, v208, v209
    v_cvt_pk_bf16_f32 v41, v210, v211
    ds_read_b128 a[32:35], v2 offset:8192
    ds_read_b128 a[36:39], v3 offset:8192
    v_mfma_f32_32x32x16_bf16 v[64:79], a[4:7], v[36:39], v[64:79]
    v_cvt_pk_bf16_f32 v42, v212, v213
    v_cvt_pk_bf16_f32 v43, v214, v215
    ds_read_b128 a[40:43], v4 offset:8192
    ds_read_b128 a[44:47], v5 offset:8192
    v_mfma_f32_32x32x16_bf16 v[64:79], a[8:11], v[40:43], v[64:79]
    v_mul_f32 v216, s61, v216
    v_mul_f32 v217, s61, v217
    v_mul_f32 v218, s61, v218
    v_mul_f32 v219, s61, v219
    v_mul_f32 v220, s61, v220
    v_mul_f32 v221, s61, v221
    v_mul_f32 v222, s61, v222
    v_mul_f32 v223, s61, v223
    v_cvt_pk_bf16_f32 v44, v216, v217
    v_cvt_pk_bf16_f32 v45, v218, v219
    v_cvt_pk_bf16_f32 v46, v220, v221
    v_cvt_pk_bf16_f32 v47, v222, v223
    ds_read_b128 a[48:51], v6 offset:8192
    ds_read_b128 a[52:55], v7 offset:8192
    v_mfma_f32_32x32x16_bf16 v[64:79], a[12:15], v[44:47], v[64:79]
    v_mul_f32 v224, s61, v224
    v_mul_f32 v225, s61, v225
    v_mul_f32 v226, s61, v226
    v_mul_f32 v227, s61, v227
    v_mul_f32 v228, s61, v228
    v_mul_f32 v229, s61, v229
    v_mul_f32 v230, s61, v230
    v_mul_f32 v231, s61, v231
    v_cvt_pk_bf16_f32 v48, v224, v225
    v_cvt_pk_bf16_f32 v49, v226, v227
    v_cvt_pk_bf16_f32 v50, v228, v229
    v_cvt_pk_bf16_f32 v51, v230, v231
    ds_read_b128 a[56:59], v8 offset:8192
    ds_read_b128 a[60:63], v9 offset:8192
    v_mfma_f32_32x32x16_bf16 v[64:79], a[16:19], v[48:51], v[64:79]
    v_mul_f32 v232, s61, v232
    v_mul_f32 v233, s61, v233
    v_mul_f32 v234, s61, v234
    v_mul_f32 v235, s61, v235
    v_mul_f32 v236, s61, v236
    v_mul_f32 v237, s61, v237
    v_mul_f32 v238, s61, v238
    v_mul_f32 v239, s61, v239
    v_cvt_pk_bf16_f32 v52, v232, v233
    v_cvt_pk_bf16_f32 v53, v234, v235
    v_cvt_pk_bf16_f32 v54, v236, v237
    v_cvt_pk_bf16_f32 v55, v238, v239
    s_nop 1
    v_mfma_f32_32x32x16_bf16 v[64:79], a[20:23], v[52:55], v[64:79]
    v_mul_f32 v240, s61, v240
    v_mul_f32 v241, s61, v241
    v_mul_f32 v242, s61, v242
    v_mul_f32 v243, s61, v243
    v_mul_f32 v244, s61, v244
    v_mul_f32 v245, s61, v245
    v_mul_f32 v246, s61, v246
    v_mul_f32 v247, s61, v247
    v_cvt_pk_bf16_f32 v56, v240, v241
    v_cvt_pk_bf16_f32 v57, v242, v243
    v_cvt_pk_bf16_f32 v58, v244, v245
    v_cvt_pk_bf16_f32 v59, v246, v247
    s_nop 1
    v_mfma_f32_32x32x16_bf16 v[64:79], a[24:27], v[56:59], v[64:79]
    v_mul_f32 v248, s61, v248
    v_mul_f32 v249, s61, v249
    v_mul_f32 v250, s61, v250
    v_mul_f32 v251, s61, v251
    v_mul_f32 v252, s61, v252
    v_mul_f32 v253, s61, v253
    v_mul_f32 v254, s61, v254
    v_mul_f32 v255, s61, v255
    v_cvt_pk_bf16_f32 v60, v248, v249
    v_cvt_pk_bf16_f32 v61, v250, v251
    v_cvt_pk_bf16_f32 v62, v252, v253
    v_cvt_pk_bf16_f32 v63, v254, v255
    s_nop 1
    v_mfma_f32_32x32x16_bf16 v[64:79], a[28:31], v[60:63], v[64:79]
    s_add_u32 s53, s53, 32768
    s_cmp_eq_u32 s53, 163840
    s_cselect_b32 s53, 0, s53
    s_waitcnt lgkmcnt(0)
    v_add_u32 v2, s53, v16
    v_xor_b32 v3, 32, v2
    v_xor_b32 v4, 64, v2
    v_xor_b32 v5, 96, v2
    v_xor_b32 v6, 128, v2
    v_xor_b32 v7, 160, v2
    v_xor_b32 v8, 192, v2
    v_xor_b32 v9, 224, v2
    v_add_u32 v10, s53, v17
    v_xor_b32 v11, 64, v10
    v_xor_b32 v12, 128, v10
    v_xor_b32 v13, 192, v10
    s_waitcnt vmcnt(0) lgkmcnt(0)
    v_max3_f32 v18, v64, v65, v66
    v_max3_f32 v19, v67, v68, v69
    v_max3_f32 v18, v70, v71, v18
    v_max3_f32 v19, v72, v73, v19
    v_max3_f32 v18, v74, v75, v18
    v_max3_f32 v19, v76, v77, v19
    v_max3_f32 v18, v78, v79, v18
    v_max_f32 v18, v18, v19
    v_mov_b32 v19, v18
    s_nop 1
    v_permlane32_swap_b32 v18, v19
    v_max_f32 v18, v18, v19
    v_sub_f32 v112, 0xc0e00000, v18
    v_mov_b32 v113, v112
    v_mov_b32 v114, v112
    v_mov_b32 v115, v112
    v_mov_b32 v116, v112
    v_mov_b32 v117, v112
    v_mov_b32 v118, v112
    v_mov_b32 v119, v112
    v_mov_b32 v120, v112
    v_mov_b32 v121, v112
    v_mov_b32 v122, v112
    v_mov_b32 v123, v112
    v_mov_b32 v124, v112
    v_mov_b32 v125, v112
    v_mov_b32 v126, v112
    v_mov_b32 v127, v112
    s_mov_b32 s60, 0
    s_nop 0
    v_mfma_f32_32x32x16_bf16 v[80:95], a[32:35], v[32:35], v[112:127]
    v_add_f32 v64, v112, v64
    v_add_f32 v65, v112, v65
    v_exp_f32 v28, v64
    v_add_f32 v66, v112, v66
    v_exp_f32 v29, v65
    v_mfma_f32_32x32x16_bf16 v[80:95], a[36:39], v[36:39], v[80:95]
    v_add_f32 v67, v112, v67
    v_exp_f32 v30, v66
    v_add_f32 v68, v112, v68
    v_cvt_pk_bf16_f32 v96, v28, v29
    v_exp_f32 v31, v67
    v_mfma_f32_32x32x16_bf16 v[80:95], a[40:43], v[40:43], v[80:95]
    v_add_f32 v69, v112, v69
    v_exp_f32 v28, v68
    v_add_f32 v70, v112, v70
    v_cvt_pk_bf16_f32 v97, v30, v31
    v_exp_f32 v29, v69
    s_barrier
    ds_read_b128 a[0:3], v2 offset:0
    ds_read_b128 a[4:7], v3 offset:0
    ds_read_b128 a[8:11], v4 offset:0
    v_mfma_f32_32x32x16_bf16 v[80:95], a[44:47], v[44:47], v[80:95]
    v_add_f32 v71, v112, v71
    v_exp_f32 v30, v70
    v_add_f32 v72, v112, v72
    v_cvt_pk_bf16_f32 v98, v28, v29
    v_exp_f32 v31, v71
    ds_read_b128 a[12:15], v5 offset:0
    ds_read_b128 a[16:19], v6 offset:0
    ds_read_b128 a[20:23], v7 offset:0
    v_mfma_f32_32x32x16_bf16 v[80:95], a[48:51], v[48:51], v[80:95]
    v_add_f32 v73, v112, v73
    v_exp_f32 v28, v72
    v_add_f32 v74, v112, v74
    v_cvt_pk_bf16_f32 v99, v30, v31
    v_exp_f32 v29, v73
    ds_read_b128 a[24:27], v8 offset:0
    ds_read_b128 a[28:31], v9 offset:0
    v_mfma_f32_32x32x16_bf16 v[80:95], a[52:55], v[52:55], v[80:95]
    v_add_f32 v75, v112, v75
    v_exp_f32 v30, v74
    v_add_f32 v76, v112, v76
    v_cvt_pk_bf16_f32 v100, v28, v29
    v_exp_f32 v31, v75
    ds_read_b64_tr_b16 a[64:65], v10 offset:16384
    ds_read_b64_tr_b16 a[66:67], v10 offset:18432
    ds_read_b64_tr_b16 a[68:69], v11 offset:16384
    v_mfma_f32_32x32x16_bf16 v[80:95], a[56:59], v[56:59], v[80:95]
    v_add_f32 v77, v112, v77
    v_exp_f32 v28, v76
    v_add_f32 v78, v112, v78
    v_cvt_pk_bf16_f32 v101, v30, v31
    v_exp_f32 v29, v77
    ds_read_b64_tr_b16 a[70:71], v11 offset:18432
    ds_read_b64_tr_b16 a[72:73], v12 offset:16384
    ds_read_b64_tr_b16 a[74:75], v12 offset:18432
    v_mfma_f32_32x32x16_bf16 v[80:95], a[60:63], v[60:63], v[80:95]
    v_add_f32 v79, v112, v79
    v_exp_f32 v30, v78
    v_cvt_pk_bf16_f32 v102, v28, v29
    v_exp_f32 v31, v79
    s_nop 0
    v_cvt_pk_bf16_f32 v103, v30, v31
    ds_read_b64_tr_b16 a[76:77], v13 offset:16384
    ds_read_b64_tr_b16 a[78:79], v13 offset:18432
    v_mov_b32 v192, -1
    v_mov_b32 v193, -1
    v_mov_b32 v194, -1
    v_mov_b32 v195, -1
    v_mov_b32 v196, v1
    s_nop 0
    s_branch L_kv_entry
.p2align 3
L_kv:
    s_barrier
    ds_read_b128 a[0:3], v2 offset:0
    v_mfma_f32_32x32x16_bf16 v[128:143], a[96:99], v[104:107], v[128:143]
    v_exp_f32 v28, v72
    ds_read_b128 a[4:7], v3 offset:0
    ds_read_b128 a[8:11], v4 offset:0
    v_cvt_pk_bf16_f32 v99, v30, v31
    v_mfma_f32_32x32x16_bf16 v[144:159], a[100:103], v[104:107], v[144:159]
    v_exp_f32 v29, v73
    ds_read_b128 a[12:15], v5 offset:0
    ds_read_b128 a[16:19], v6 offset:0
    v_mfma_f32_32x32x16_bf16 v[160:175], a[104:107], v[104:107], v[160:175]
    v_exp_f32 v30, v74
    ds_read_b128 a[20:23], v7 offset:0
    ds_read_b128 a[24:27], v8 offset:0
    v_cvt_pk_bf16_f32 v100, v28, v29
    v_mfma_f32_32x32x16_bf16 v[176:191], a[108:111], v[104:107], v[176:191]
    v_exp_f32 v31, v75
    ds_read_b128 a[28:31], v9 offset:0
    ds_read_b64_tr_b16 a[64:65], v10 offset:16384
    v_or3_b32 v20, v20, v99, v100
    v_mfma_f32_32x32x16_bf16 v[128:143], a[112:115], v[108:111], v[128:143]
    v_exp_f32 v28, v76
    ds_read_b64_tr_b16 a[66:67], v10 offset:18432
    ds_read_b64_tr_b16 a[68:69], v11 offset:16384
    v_cvt_pk_bf16_f32 v101, v30, v31
    v_mfma_f32_32x32x16_bf16 v[144:159], a[116:119], v[108:111], v[144:159]
    v_exp_f32 v29, v77
    ds_read_b64_tr_b16 a[70:71], v11 offset:18432
    ds_read_b64_tr_b16 a[72:73], v12 offset:16384
    v_mfma_f32_32x32x16_bf16 v[160:175], a[120:123], v[108:111], v[160:175]
    v_exp_f32 v30, v78
    ds_read_b64_tr_b16 a[74:75], v12 offset:18432
    ds_read_b64_tr_b16 a[76:77], v13 offset:16384
    v_cvt_pk_bf16_f32 v102, v28, v29
    v_mfma_f32_32x32x16_bf16 v[176:191], a[124:127], v[108:111], v[176:191]
    v_exp_f32 v31, v79
    ds_read_b64_tr_b16 a[78:79], v13 offset:18432
    v_or3_b32 v20, v20, v101, v102
    v_cvt_pk_bf16_f32 v103, v30, v31
    v_mfma_f32_16x16x32_bf16 v[22:25], a[132:135], v[104:107], v[22:25]
    v_bitop3_b32 v20, v20, v103, s63 bitop3:0xa8
    v_cmp_ne_u32 vcc, 0, v20
    v_mfma_f32_16x16x32_bf16 v[22:25], a[132:135], v[108:111], v[22:25]
    s_cbranch_vccnz L_slow_a
L_back_a:
L_kv_entry:
    s_waitcnt lgkmcnt(8)
    v_mfma_f32_32x32x16_bf16 v[64:79], a[0:3], v[32:35], v[112:127]
    v_exp_f32 v28, v80
    ds_read_b64_tr_b16 a[80:81], v10 offset:20480
    ds_read_b64_tr_b16 a[82:83], v10 offset:22528
    v_mfma_f32_32x32x16_bf16 v[64:79], a[4:7], v[36:39], v[64:79]
    v_exp_f32 v29, v81
    ds_read_b64_tr_b16 a[84:85], v11 offset:20480
    ds_read_b64_tr_b16 a[86:87], v11 offset:22528
    v_mfma_f32_32x32x16_bf16 v[64:79], a[8:11], v[40:43], v[64:79]
    v_exp_f32 v30, v82
    ds_read_b64_tr_b16 a[88:89], v12 offset:20480
    ds_read_b64_tr_b16 a[90:91], v12 offset:22528
    v_cvt_pk_bf16_f32 v104, v28, v29
    v_mfma_f32_32x32x16_bf16 v[64:79], a[12:15], v[44:47], v[64:79]
    v_exp_f32 v31, v83
    ds_read_b64_tr_b16 a[92:93], v13 offset:20480
    ds_read_b64_tr_b16 a[94:95], v13 offset:22528
    v_mfma_f32_32x32x16_bf16 v[64:79], a[16:19], v[48:51], v[64:79]
    v_exp_f32 v28, v84
    ds_read_b128 a[32:35], v2 offset:8192
    ds_read_b128 a[36:39], v3 offset:8192
    v_cvt_pk_bf16_f32 v105, v30, v31
    v_mfma_f32_32x32x16_bf16 v[64:79], a[20:23], v[52:55], v[64:79]
    v_exp_f32 v29, v85
    ds_read_b128 a[40:43], v4 offset:8192
    ds_read_b128 a[44:47], v5 offset:8192
    v_mfma_f32_32x32x16_bf16 v[64:79], a[24:27], v[56:59], v[64:79]
    v_exp_f32 v30, v86
    ds_read_b128 a[48:51], v6 offset:8192
    ds_read_b128 a[52:55], v7 offset:8192
    v_cvt_pk_bf16_f32 v106, v28, v29
    v_mfma_f32_32x32x16_bf16 v[64:79], a[28:31], v[60:63], v[64:79]
    v_exp_f32 v31, v87
    ds_read_b128 a[56:59], v8 offset:8192
    v_or3_b32 v20, v104, v105, v106
    s_waitcnt lgkmcnt(7)
    v_mfma_f32_32x32x16_bf16 v[128:143], a[64:67], v[96:99], v[128:143]
    v_exp_f32 v28, v88
    ds_read_b128 a[60:63], v9 offset:8192
    s_add_u32 s53, s53, 32768
    v_cvt_pk_bf16_f32 v107, v30, v31
    v_mfma_f32_32x32x16_bf16 v[144:159], a[68:71], v[96:99], v[144:159]
    v_exp_f32 v29, v89
    buffer_store_dwordx4 v[192:195], v196, s[36:39], 0 offen offset:0 sc1
    s_cmp_eq_u32 s53, 163840
    s_cselect_b32 s53, 0, s53
    ds_read_b64_tr_b16 a[96:97], v10 offset:24576
    v_mfma_f32_32x32x16_bf16 v[160:175], a[72:75], v[96:99], v[160:175]
    v_exp_f32 v30, v90
    ds_read_b64_tr_b16 a[98:99], v10 offset:26624
    ds_read_b64_tr_b16 a[100:101], v11 offset:24576
    v_cvt_pk_bf16_f32 v108, v28, v29
    v_mfma_f32_32x32x16_bf16 v[176:191], a[76:79], v[96:99], v[176:191]
    v_exp_f32 v31, v91
    ds_read_b64_tr_b16 a[102:103], v11 offset:26624
    ds_read_b64_tr_b16 a[104:105], v12 offset:24576
    v_or3_b32 v20, v20, v107, v108
    v_mfma_f32_32x32x16_bf16 v[128:143], a[80:83], v[100:103], v[128:143]
    v_exp_f32 v28, v92
    ds_read_b64_tr_b16 a[106:107], v12 offset:26624
    ds_read_b64_tr_b16 a[108:109], v13 offset:24576
    v_cvt_pk_bf16_f32 v109, v30, v31
    v_mfma_f32_32x32x16_bf16 v[144:159], a[84:87], v[100:103], v[144:159]
    v_exp_f32 v29, v93
    ds_read_b64_tr_b16 a[110:111], v13 offset:26624
    ds_read_b64_tr_b16 a[112:113], v10 offset:28672
    v_mfma_f32_32x32x16_bf16 v[160:175], a[88:91], v[100:103], v[160:175]
    v_exp_f32 v30, v94
    ds_read_b64_tr_b16 a[114:115], v10 offset:30720
    ds_read_b64_tr_b16 a[116:117], v11 offset:28672
    v_cvt_pk_bf16_f32 v110, v28, v29
    v_mfma_f32_32x32x16_bf16 v[176:191], a[92:95], v[100:103], v[176:191]
    v_exp_f32 v31, v95
    ds_read_b64_tr_b16 a[118:119], v11 offset:30720
    v_or3_b32 v20, v20, v109, v110
    v_cvt_pk_bf16_f32 v111, v30, v31
    v_mfma_f32_16x16x32_bf16 v[22:25], a[132:135], v[96:99], v[22:25]
    v_bitop3_b32 v20, v20, v111, s63 bitop3:0xa8
    v_cmp_ne_u32 vcc, 0, v20
    v_mfma_f32_16x16x32_bf16 v[22:25], a[132:135], v[100:103], v[22:25]
    s_cbranch_vccnz L_slow_b
L_back_b:
    s_waitcnt lgkmcnt(12)
    v_mfma_f32_32x32x16_bf16 v[80:95], a[32:35], v[32:35], v[112:127]
    v_exp_f32 v28, v64
    ds_read_b64_tr_b16 a[120:121], v12 offset:28672
    ds_read_b64_tr_b16 a[122:123], v12 offset:30720
    v_mfma_f32_32x32x16_bf16 v[80:95], a[36:39], v[36:39], v[80:95]
    v_exp_f32 v29, v65
    buffer_store_dwordx4 v[192:195], v196, s[36:39], 0 offen offset:1024 sc1
    ds_read_b64_tr_b16 a[124:125], v13 offset:28672
    ds_read_b64_tr_b16 a[126:127], v13 offset:30720
    v_mfma_f32_32x32x16_bf16 v[80:95], a[40:43], v[40:43], v[80:95]
    v_exp_f32 v30, v66
    v_add_u32 v2, s53, v16
    v_xor_b32 v3, 32, v2
    v_cvt_pk_bf16_f32 v96, v28, v29
    v_mfma_f32_32x32x16_bf16 v[80:95], a[44:47], v[44:47], v[80:95]
    v_exp_f32 v31, v67
    v_add_u32 v196, 2048, v196
    v_xor_b32 v4, 64, v2
    v_xor_b32 v5, 96, v2
    v_mfma_f32_32x32x16_bf16 v[80:95], a[48:51], v[48:51], v[80:95]
    v_exp_f32 v28, v68
    v_xor_b32 v6, 128, v2
    v_xor_b32 v7, 160, v2
    v_cvt_pk_bf16_f32 v97, v30, v31
    v_mfma_f32_32x32x16_bf16 v[80:95], a[52:55], v[52:55], v[80:95]
    v_exp_f32 v29, v69
    v_xor_b32 v8, 192, v2
    v_xor_b32 v9, 224, v2
    v_mfma_f32_32x32x16_bf16 v[80:95], a[56:59], v[56:59], v[80:95]
    v_exp_f32 v30, v70
    v_add_u32 v10, s53, v17
    v_xor_b32 v11, 64, v10
    v_cvt_pk_bf16_f32 v98, v28, v29
    v_mfma_f32_32x32x16_bf16 v[80:95], a[60:63], v[60:63], v[80:95]
    v_exp_f32 v31, v71
    v_xor_b32 v12, 128, v10
    v_xor_b32 v13, 192, v10
    v_or3_b32 v20, v96, v97, v98
    s_add_u32 s60, s60, 1
    s_cmp_lt_u32 s60, 7
    s_waitcnt vmcnt(2) lgkmcnt(0)
    s_cbranch_scc1 L_kv
    s_barrier
    ds_read_b64_tr_b16 a[64:65], v10 offset:16384
    ds_read_b64_tr_b16 a[66:67], v10 offset:18432
    v_mfma_f32_32x32x16_bf16 v[128:143], a[96:99], v[104:107], v[128:143]
    v_exp_f32 v28, v72
    ds_read_b64_tr_b16 a[68:69], v11 offset:16384
    ds_read_b64_tr_b16 a[70:71], v11 offset:18432
    v_cvt_pk_bf16_f32 v99, v30, v31
    v_mfma_f32_32x32x16_bf16 v[144:159], a[100:103], v[104:107], v[144:159]
    v_exp_f32 v29, v73
    ds_read_b64_tr_b16 a[72:73], v12 offset:16384
    ds_read_b64_tr_b16 a[74:75], v12 offset:18432
    ds_read_b64_tr_b16 a[76:77], v13 offset:16384
    v_mfma_f32_32x32x16_bf16 v[160:175], a[104:107], v[104:107], v[160:175]
    v_exp_f32 v30, v74
    ds_read_b64_tr_b16 a[78:79], v13 offset:18432
    ds_read_b64_tr_b16 a[80:81], v10 offset:20480
    v_cvt_pk_bf16_f32 v100, v28, v29
    v_mfma_f32_32x32x16_bf16 v[176:191], a[108:111], v[104:107], v[176:191]
    v_exp_f32 v31, v75
    ds_read_b64_tr_b16 a[82:83], v10 offset:22528
    ds_read_b64_tr_b16 a[84:85], v11 offset:20480
    v_or3_b32 v20, v20, v99, v100
    v_mfma_f32_32x32x16_bf16 v[128:143], a[112:115], v[108:111], v[128:143]
    v_exp_f32 v28, v76
    ds_read_b64_tr_b16 a[86:87], v11 offset:22528
    ds_read_b64_tr_b16 a[88:89], v12 offset:20480
    v_cvt_pk_bf16_f32 v101, v30, v31
    v_mfma_f32_32x32x16_bf16 v[144:159], a[116:119], v[108:111], v[144:159]
    v_exp_f32 v29, v77
    ds_read_b64_tr_b16 a[90:91], v12 offset:22528
    ds_read_b64_tr_b16 a[92:93], v13 offset:20480
    ds_read_b64_tr_b16 a[94:95], v13 offset:22528
    v_mfma_f32_32x32x16_bf16 v[160:175], a[120:123], v[108:111], v[160:175]
    v_exp_f32 v30, v78
    ds_read_b64_tr_b16 a[96:97], v10 offset:24576
    ds_read_b64_tr_b16 a[98:99], v10 offset:26624
    v_cvt_pk_bf16_f32 v102, v28, v29
    v_mfma_f32_32x32x16_bf16 v[176:191], a[124:127], v[108:111], v[176:191]
    v_exp_f32 v31, v79
    ds_read_b64_tr_b16 a[100:101], v11 offset:24576
    v_or3_b32 v20, v20, v101, v102
    v_cvt_pk_bf16_f32 v103, v30, v31
    v_mfma_f32_16x16x32_bf16 v[22:25], a[132:135], v[104:107], v[22:25]
    v_bitop3_b32 v20, v20, v103, s63 bitop3:0xa8
    v_cmp_ne_u32 vcc, 0, v20
    v_mfma_f32_16x16x32_bf16 v[22:25], a[132:135], v[108:111], v[22:25]
    s_cbranch_vccnz L_slow_c
L_back_c:
    s_waitcnt lgkmcnt(3)
    v_mfma_f32_32x32x16_bf16 v[128:143], a[64:67], v[96:99], v[128:143]
    v_exp_f32 v28, v80
    ds_read_b64_tr_b16 a[112:113], v10 offset:28672
    ds_read_b64_tr_b16 a[102:103], v11 offset:26624
    v_exp_f32 v29, v81
    v_mfma_f32_32x32x16_bf16 v[144:159], a[68:71], v[96:99], v[144:159]
    v_exp_f32 v30, v82
    ds_read_b64_tr_b16 a[114:115], v10 offset:30720
    v_cvt_pk_bf16_f32 v104, v28, v29
    v_exp_f32 v31, v83
    v_mfma_f32_32x32x16_bf16 v[160:175], a[72:75], v[96:99], v[160:175]
    v_exp_f32 v28, v84
    ds_read_b64_tr_b16 a[116:117], v11 offset:28672
    v_cvt_pk_bf16_f32 v105, v30, v31
    v_exp_f32 v29, v85
    v_mfma_f32_32x32x16_bf16 v[176:191], a[76:79], v[96:99], v[176:191]
    v_exp_f32 v30, v86
    ds_read_b64_tr_b16 a[118:119], v11 offset:30720
    v_cvt_pk_bf16_f32 v106, v28, v29
    v_exp_f32 v31, v87
    v_or3_b32 v20, v104, v105, v106
    v_mfma_f32_32x32x16_bf16 v[128:143], a[80:83], v[100:103], v[128:143]
    v_exp_f32 v28, v88
    ds_read_b64_tr_b16 a[120:121], v12 offset:28672
    v_cvt_pk_bf16_f32 v107, v30, v31
    v_exp_f32 v29, v89
    v_mfma_f32_32x32x16_bf16 v[144:159], a[84:87], v[100:103], v[144:159]
    v_exp_f32 v30, v90
    ds_read_b64_tr_b16 a[122:123], v12 offset:30720
    v_cvt_pk_bf16_f32 v108, v28, v29
    v_exp_f32 v31, v91
    v_or3_b32 v20, v20, v107, v108
    v_mfma_f32_32x32x16_bf16 v[160:175], a[88:91], v[100:103], v[160:175]
    v_exp_f32 v28, v92
    ds_read_b64_tr_b16 a[124:125], v13 offset:28672
    v_cvt_pk_bf16_f32 v109, v30, v31
    v_exp_f32 v29, v93
    v_mfma_f32_32x32x16_bf16 v[176:191], a[92:95], v[100:103], v[176:191]
    v_exp_f32 v30, v94
    ds_read_b64_tr_b16 a[126:127], v13 offset:30720
    ds_read_b64_tr_b16 a[104:105], v12 offset:24576
    ds_read_b64_tr_b16 a[106:107], v12 offset:26624
    v_cvt_pk_bf16_f32 v110, v28, v29
    v_mfma_f32_16x16x32_bf16 v[22:25], a[132:135], v[96:99], v[22:25]
    v_exp_f32 v31, v95
    v_or3_b32 v20, v20, v109, v110
    v_cvt_pk_bf16_f32 v111, v30, v31
    v_bitop3_b32 v20, v20, v111, s63 bitop3:0xa8
    v_cmp_ne_u32 vcc, 0, v20
    v_mfma_f32_16x16x32_bf16 v[22:25], a[132:135], v[100:103], v[22:25]
    s_cbranch_vccnz L_slow_d
L_back_d:
    ds_read_b64_tr_b16 a[108:109], v13 offset:24576
    ds_read_b64_tr_b16 a[110:111], v13 offset:26624
    s_waitcnt lgkmcnt(0)
    s_barrier
    v_mfma_f32_16x16x32_bf16 v[22:25], a[132:135], v[104:107], v[22:25]
    v_lshrrev_b32 v4, 2, v0
    v_mul_u32_u24 v4, 288, v4
    v_mfma_f32_16x16x32_bf16 v[22:25], a[132:135], v[108:111], v[22:25]
    v_and_b32 v3, 3, v0
    v_lshl_add_u32 v4, v3, 3, v4
    v_mfma_f32_32x32x16_bf16 v[128:143], a[96:99], v[104:107], v[128:143]
    v_add_u32 v3, 98304, v4
    v_add_u32 v5, 64512, v4
    v_mfma_f32_32x32x16_bf16 v[128:143], a[112:115], v[108:111], v[128:143]
    v_mfma_f32_32x32x16_bf16 v[144:159], a[100:103], v[104:107], v[144:159]
    s_nop 0
    v_rcp_f32 v21, v22
    v_mfma_f32_32x32x16_bf16 v[144:159], a[116:119], v[108:111], v[144:159]
    s_nop 7
    v_pk_mul_f32 v[128:129], v[128:129], v[20:21] op_sel:[0,1] op_sel_hi:[1,1]
    v_pk_mul_f32 v[130:131], v[130:131], v[20:21] op_sel:[0,1] op_sel_hi:[1,1]
    v_pk_mul_f32 v[132:133], v[132:133], v[20:21] op_sel:[0,1] op_sel_hi:[1,1]
    v_pk_mul_f32 v[134:135], v[134:135], v[20:21] op_sel:[0,1] op_sel_hi:[1,1]
    v_cvt_pk_bf16_f32 v192, v128, v129
    v_cvt_pk_bf16_f32 v193, v130, v131
    v_cvt_pk_bf16_f32 v194, v132, v133
    v_cvt_pk_bf16_f32 v195, v134, v135
    v_pk_mul_f32 v[136:137], v[136:137], v[20:21] op_sel:[0,1] op_sel_hi:[1,1]
    v_mfma_f32_32x32x16_bf16 v[160:175], a[104:107], v[104:107], v[160:175]
    v_pk_mul_f32 v[138:139], v[138:139], v[20:21] op_sel:[0,1] op_sel_hi:[1,1]
    v_pk_mul_f32 v[140:141], v[140:141], v[20:21] op_sel:[0,1] op_sel_hi:[1,1]
    v_pk_mul_f32 v[142:143], v[142:143], v[20:21] op_sel:[0,1] op_sel_hi:[1,1]
    v_cvt_pk_bf16_f32 v196, v136, v137
    v_cvt_pk_bf16_f32 v197, v138, v139
    v_cvt_pk_bf16_f32 v198, v140, v141
    v_cvt_pk_bf16_f32 v199, v142, v143
    v_permlane16_swap_b32 v192, v196
    v_permlane16_swap_b32 v193, v197
    v_mfma_f32_32x32x16_bf16 v[160:175], a[120:123], v[108:111], v[160:175]
    v_permlane16_swap_b32 v194, v198
    v_permlane16_swap_b32 v195, v199
    buffer_store_dwordx4 v[192:195], v1, s[48:51], s68 offen offset:0 sc1
    buffer_store_dwordx4 v[196:199], v1, s[48:51], s68 offen offset:1024 sc1
    v_pk_mul_f32 v[144:145], v[144:145], v[20:21] op_sel:[0,1] op_sel_hi:[1,1]
    v_pk_mul_f32 v[146:147], v[146:147], v[20:21] op_sel:[0,1] op_sel_hi:[1,1]
    v_pk_mul_f32 v[148:149], v[148:149], v[20:21] op_sel:[0,1] op_sel_hi:[1,1]
    v_pk_mul_f32 v[150:151], v[150:151], v[20:21] op_sel:[0,1] op_sel_hi:[1,1]
    v_cvt_pk_bf16_f32 v200, v144, v145
    v_mfma_f32_32x32x16_bf16 v[176:191], a[108:111], v[104:107], v[176:191]
    v_cvt_pk_bf16_f32 v201, v146, v147
    v_cvt_pk_bf16_f32 v202, v148, v149
    v_cvt_pk_bf16_f32 v203, v150, v151
    v_pk_mul_f32 v[152:153], v[152:153], v[20:21] op_sel:[0,1] op_sel_hi:[1,1]
    v_pk_mul_f32 v[154:155], v[154:155], v[20:21] op_sel:[0,1] op_sel_hi:[1,1]
    v_pk_mul_f32 v[156:157], v[156:157], v[20:21] op_sel:[0,1] op_sel_hi:[1,1]
    v_pk_mul_f32 v[158:159], v[158:159], v[20:21] op_sel:[0,1] op_sel_hi:[1,1]
    v_cvt_pk_bf16_f32 v204, v152, v153
    v_cvt_pk_bf16_f32 v205, v154, v155
    v_mfma_f32_32x32x16_bf16 v[176:191], a[124:127], v[108:111], v[176:191]
    v_cvt_pk_bf16_f32 v206, v156, v157
    v_cvt_pk_bf16_f32 v207, v158, v159
    v_permlane16_swap_b32 v200, v204
    v_permlane16_swap_b32 v201, v205
    v_permlane16_swap_b32 v202, v206
    v_permlane16_swap_b32 v203, v207
    buffer_store_dwordx4 v[200:203], v1, s[48:51], s68 offen offset:2048 sc1
    buffer_store_dwordx4 v[204:207], v1, s[48:51], s68 offen offset:3072 sc1
    v_pk_mul_f32 v[160:161], v[160:161], v[20:21] op_sel:[0,1] op_sel_hi:[1,1]
    v_pk_mul_f32 v[162:163], v[162:163], v[20:21] op_sel:[0,1] op_sel_hi:[1,1]
    v_pk_mul_f32 v[164:165], v[164:165], v[20:21] op_sel:[0,1] op_sel_hi:[1,1]
    v_pk_mul_f32 v[166:167], v[166:167], v[20:21] op_sel:[0,1] op_sel_hi:[1,1]
    v_cvt_pk_bf16_f32 v208, v160, v161
    v_cvt_pk_bf16_f32 v209, v162, v163
    v_cvt_pk_bf16_f32 v210, v164, v165
    v_cvt_pk_bf16_f32 v211, v166, v167
    v_pk_mul_f32 v[168:169], v[168:169], v[20:21] op_sel:[0,1] op_sel_hi:[1,1]
    v_pk_mul_f32 v[170:171], v[170:171], v[20:21] op_sel:[0,1] op_sel_hi:[1,1]
    v_pk_mul_f32 v[172:173], v[172:173], v[20:21] op_sel:[0,1] op_sel_hi:[1,1]
    v_pk_mul_f32 v[174:175], v[174:175], v[20:21] op_sel:[0,1] op_sel_hi:[1,1]
    v_cvt_pk_bf16_f32 v212, v168, v169
    v_cvt_pk_bf16_f32 v213, v170, v171
    v_cvt_pk_bf16_f32 v214, v172, v173
    v_cvt_pk_bf16_f32 v215, v174, v175
    v_permlane16_swap_b32 v208, v212
    v_permlane16_swap_b32 v209, v213
    v_permlane16_swap_b32 v210, v214
    v_permlane16_swap_b32 v211, v215
    buffer_store_dwordx4 v[208:211], v1, s[48:51], s69 offen offset:0 sc1
    buffer_store_dwordx4 v[212:215], v1, s[48:51], s69 offen offset:1024 sc1
    v_pk_mul_f32 v[176:177], v[176:177], v[20:21] op_sel:[0,1] op_sel_hi:[1,1]
    v_pk_mul_f32 v[178:179], v[178:179], v[20:21] op_sel:[0,1] op_sel_hi:[1,1]
    v_pk_mul_f32 v[180:181], v[180:181], v[20:21] op_sel:[0,1] op_sel_hi:[1,1]
    v_pk_mul_f32 v[182:183], v[182:183], v[20:21] op_sel:[0,1] op_sel_hi:[1,1]
    v_cvt_pk_bf16_f32 v216, v176, v177
    v_cvt_pk_bf16_f32 v217, v178, v179
    v_cvt_pk_bf16_f32 v218, v180, v181
    v_cvt_pk_bf16_f32 v219, v182, v183
    v_pk_mul_f32 v[184:185], v[184:185], v[20:21] op_sel:[0,1] op_sel_hi:[1,1]
    v_pk_mul_f32 v[186:187], v[186:187], v[20:21] op_sel:[0,1] op_sel_hi:[1,1]
    v_pk_mul_f32 v[188:189], v[188:189], v[20:21] op_sel:[0,1] op_sel_hi:[1,1]
    v_pk_mul_f32 v[190:191], v[190:191], v[20:21] op_sel:[0,1] op_sel_hi:[1,1]
    v_cvt_pk_bf16_f32 v220, v184, v185
    v_cvt_pk_bf16_f32 v221, v186, v187
    v_cvt_pk_bf16_f32 v222, v188, v189
    v_cvt_pk_bf16_f32 v223, v190, v191
    v_permlane16_swap_b32 v216, v220
    v_permlane16_swap_b32 v217, v221
    v_permlane16_swap_b32 v218, v222
    v_permlane16_swap_b32 v219, v223
    buffer_store_dwordx4 v[216:219], v1, s[48:51], s69 offen offset:2048 sc1
    buffer_store_dwordx4 v[220:223], v1, s[48:51], s69 offen offset:3072 sc1
    ds_read_b64_tr_b16 a[0:1], v3 offset:0
    ds_read_b64_tr_b16 a[2:3], v3 offset:4608
    ds_read_b64_tr_b16 a[4:5], v3 offset:32
    ds_read_b64_tr_b16 a[6:7], v3 offset:4640
    ds_read_b64_tr_b16 a[8:9], v3 offset:64
    ds_read_b64_tr_b16 a[10:11], v3 offset:4672
    ds_read_b64_tr_b16 a[12:13], v3 offset:96
    ds_read_b64_tr_b16 a[14:15], v3 offset:4704
    ds_read_b64_tr_b16 a[16:17], v3 offset:128
    ds_read_b64_tr_b16 a[18:19], v3 offset:4736
    ds_read_b64_tr_b16 a[20:21], v3 offset:160
    ds_read_b64_tr_b16 a[22:23], v3 offset:4768
    s_waitcnt lgkmcnt(8)
    v_mfma_f32_16x16x32_bf16 v[32:35], a[0:3], v[192:195], 0
    ds_read_b64_tr_b16 a[24:25], v3 offset:192
    v_mov_b32 v18, 1
    v_mfma_f32_16x16x32_bf16 v[36:39], a[0:3], v[196:199], 0
    ds_read_b64_tr_b16 a[26:27], v3 offset:4800
    v_mov_b32 v28, 1
    v_mfma_f32_16x16x32_bf16 v[40:43], a[4:7], v[192:195], 0
    ds_read_b64_tr_b16 a[28:29], v3 offset:224
    v_mul_u32_u24 v10, 0, v0
    v_mfma_f32_16x16x32_bf16 v[44:47], a[4:7], v[196:199], 0
    ds_read_b64_tr_b16 a[30:31], v3 offset:4832
    v_mul_u32_u24 v11, 384, v0
    s_waitcnt lgkmcnt(8)
    v_mfma_f32_16x16x32_bf16 v[48:51], a[8:11], v[192:195], 0
    ds_read_b64_tr_b16 a[0:1], v3 offset:256
    v_accvgpr_read_b32 v6, a142
    v_mfma_f32_16x16x32_bf16 v[52:55], a[8:11], v[196:199], 0
    ds_read_b64_tr_b16 a[2:3], v3 offset:4864
    v_accvgpr_read_b32 v7, a143
    v_mfma_f32_16x16x32_bf16 v[56:59], a[12:15], v[192:195], 0
    ds_read_b64_tr_b16 a[4:5], v3 offset:9216
    v_accvgpr_read_b32 v8, a144
    v_mfma_f32_16x16x32_bf16 v[60:63], a[12:15], v[196:199], 0
    ds_read_b64_tr_b16 a[6:7], v3 offset:13824
    s_mov_b32 s63, 0xffff0000
    s_waitcnt lgkmcnt(8)
    v_mfma_f32_16x16x32_bf16 v[64:67], a[16:19], v[192:195], 0
    ds_read_b64_tr_b16 a[8:9], v3 offset:9248
    v_mfma_f32_16x16x32_bf16 v[68:71], a[16:19], v[196:199], 0
    ds_read_b64_tr_b16 a[10:11], v3 offset:13856
    v_mfma_f32_16x16x32_bf16 v[72:75], a[20:23], v[192:195], 0
    ds_read_b64_tr_b16 a[12:13], v3 offset:9280
    v_mfma_f32_16x16x32_bf16 v[76:79], a[20:23], v[196:199], 0
    ds_read_b64_tr_b16 a[14:15], v3 offset:13888
    s_waitcnt lgkmcnt(8)
    v_mfma_f32_16x16x32_bf16 v[80:83], a[24:27], v[192:195], 0
    ds_read_b64_tr_b16 a[16:17], v3 offset:9312
    v_mfma_f32_16x16x32_bf16 v[84:87], a[24:27], v[196:199], 0
    ds_read_b64_tr_b16 a[18:19], v3 offset:13920
    v_mfma_f32_16x16x32_bf16 v[88:91], a[28:31], v[192:195], 0
    ds_read_b64_tr_b16 a[20:21], v3 offset:9344
    v_mfma_f32_16x16x32_bf16 v[92:95], a[28:31], v[196:199], 0
    ds_read_b64_tr_b16 a[22:23], v3 offset:13952
    s_waitcnt lgkmcnt(8)
    v_mfma_f32_16x16x32_bf16 v[96:99], a[0:3], v[192:195], 0
    ds_read_b64_tr_b16 a[24:25], v3 offset:9376
    v_mfma_f32_16x16x32_bf16 v[100:103], a[0:3], v[196:199], 0
    ds_read_b64_tr_b16 a[26:27], v3 offset:13984
    v_mfma_f32_16x16x32_bf16 v[32:35], a[4:7], v[200:203], v[32:35]
    ds_read_b64_tr_b16 a[28:29], v3 offset:9408
    v_mfma_f32_16x16x32_bf16 v[36:39], a[4:7], v[204:207], v[36:39]
    ds_read_b64_tr_b16 a[30:31], v3 offset:14016
    s_waitcnt lgkmcnt(8)
    v_mfma_f32_16x16x32_bf16 v[40:43], a[8:11], v[200:203], v[40:43]
    ds_read_b64_tr_b16 a[0:1], v3 offset:9440
    v_mfma_f32_16x16x32_bf16 v[44:47], a[8:11], v[204:207], v[44:47]
    ds_read_b64_tr_b16 a[2:3], v3 offset:14048
    v_mfma_f32_16x16x32_bf16 v[48:51], a[12:15], v[200:203], v[48:51]
    ds_read_b64_tr_b16 a[4:5], v3 offset:9472
    v_mfma_f32_16x16x32_bf16 v[52:55], a[12:15], v[204:207], v[52:55]
    ds_read_b64_tr_b16 a[6:7], v3 offset:14080
    s_waitcnt lgkmcnt(8)
    v_mfma_f32_16x16x32_bf16 v[56:59], a[16:19], v[200:203], v[56:59]
    ds_read_b64_tr_b16 a[8:9], v3 offset:18432
    v_mfma_f32_16x16x32_bf16 v[60:63], a[16:19], v[204:207], v[60:63]
    ds_read_b64_tr_b16 a[10:11], v3 offset:23040
    v_mfma_f32_16x16x32_bf16 v[64:67], a[20:23], v[200:203], v[64:67]
    ds_read_b64_tr_b16 a[12:13], v3 offset:18464
    v_mfma_f32_16x16x32_bf16 v[68:71], a[20:23], v[204:207], v[68:71]
    ds_read_b64_tr_b16 a[14:15], v3 offset:23072
    s_waitcnt lgkmcnt(8)
    v_mfma_f32_16x16x32_bf16 v[72:75], a[24:27], v[200:203], v[72:75]
    ds_read_b64_tr_b16 a[16:17], v3 offset:18496
    v_mfma_f32_16x16x32_bf16 v[76:79], a[24:27], v[204:207], v[76:79]
    ds_read_b64_tr_b16 a[18:19], v3 offset:23104
    s_barrier
    v_mfma_f32_16x16x32_bf16 v[80:83], a[28:31], v[200:203], v[80:83]
    ds_read_b64_tr_b16 a[20:21], v3 offset:18528
    v_mfma_f32_16x16x32_bf16 v[84:87], a[28:31], v[204:207], v[84:87]
    ds_read_b64_tr_b16 a[22:23], v3 offset:23136
    s_waitcnt lgkmcnt(8)
    v_mfma_f32_16x16x32_bf16 v[88:91], a[0:3], v[200:203], v[88:91]
    ds_read_b64_tr_b16 a[24:25], v3 offset:18560
    s_nop 0
    v_mfma_f32_16x16x32_bf16 v[92:95], a[0:3], v[204:207], v[92:95]
    ds_read_b64_tr_b16 a[26:27], v3 offset:23168
    s_mov_b64 exec, s[44:45]
    buffer_load_dword v28, v11, s[48:51], s42 offen sc1
    s_mov_b64 exec, -1
    v_mfma_f32_16x16x32_bf16 v[96:99], a[4:7], v[200:203], v[96:99]
    ds_read_b64_tr_b16 a[28:29], v3 offset:18592
    v_mfma_f32_16x16x32_bf16 v[100:103], a[4:7], v[204:207], v[100:103]
    ds_read_b64_tr_b16 a[30:31], v3 offset:23200
    s_waitcnt lgkmcnt(8)
    v_mfma_f32_16x16x32_bf16 v[32:35], a[8:11], v[208:211], v[32:35]
    ds_read_b64_tr_b16 a[0:1], v3 offset:18624
    v_mfma_f32_16x16x32_bf16 v[36:39], a[8:11], v[212:215], v[36:39]
    ds_read_b64_tr_b16 a[2:3], v3 offset:23232
    v_mfma_f32_16x16x32_bf16 v[40:43], a[12:15], v[208:211], v[40:43]
    ds_read_b64_tr_b16 a[4:5], v3 offset:18656
    v_mfma_f32_16x16x32_bf16 v[44:47], a[12:15], v[212:215], v[44:47]
    ds_read_b64_tr_b16 a[6:7], v3 offset:23264
    s_waitcnt lgkmcnt(8)
    v_mfma_f32_16x16x32_bf16 v[48:51], a[16:19], v[208:211], v[48:51]
    ds_read_b64_tr_b16 a[8:9], v3 offset:18688
    v_mfma_f32_16x16x32_bf16 v[52:55], a[16:19], v[212:215], v[52:55]
    ds_read_b64_tr_b16 a[10:11], v3 offset:23296
    v_mfma_f32_16x16x32_bf16 v[56:59], a[20:23], v[208:211], v[56:59]
    ds_read_b64_tr_b16 a[12:13], v3 offset:27648
    v_mfma_f32_16x16x32_bf16 v[60:63], a[20:23], v[212:215], v[60:63]
    ds_read_b64_tr_b16 a[14:15], v3 offset:32256
    s_waitcnt lgkmcnt(8)
    v_mfma_f32_16x16x32_bf16 v[64:67], a[24:27], v[208:211], v[64:67]
    ds_read_b64_tr_b16 a[16:17], v3 offset:27680
    v_mfma_f32_16x16x32_bf16 v[68:71], a[24:27], v[212:215], v[68:71]
    ds_read_b64_tr_b16 a[18:19], v3 offset:32288
    v_mfma_f32_16x16x32_bf16 v[72:75], a[28:31], v[208:211], v[72:75]
    ds_read_b64_tr_b16 a[20:21], v3 offset:27712
    s_nop 0
    v_mfma_f32_16x16x32_bf16 v[76:79], a[28:31], v[212:215], v[76:79]
    ds_read_b64_tr_b16 a[22:23], v3 offset:32320
    s_mov_b64 exec, 1
    s_waitcnt vmcnt(0)
    buffer_store_dword v18, v10, s[48:51], s76 offen
    s_mov_b64 exec, -1
    s_mov_b32 s60, 0
    v_cmp_ne_u32 vcc, 1, v28
    s_cbranch_vccz L_spo_o
    s_mov_b64 exec, s[44:45]
    buffer_load_dword v28, v11, s[48:51], s42 offen sc1
    s_mov_b64 exec, -1
L_sp_o:
    s_waitcnt vmcnt(0)
    v_cmp_ne_u32 vcc, 1, v28
    s_add_u32 s60, s60, 1
    s_cmp_gt_u32 s60, 40000
    s_cbranch_scc1 L_spo_o
    s_cbranch_vccz L_spo_o
    s_cmp_lg_u32 s60, 20
    s_cbranch_scc1 L_spn_o
    s_mov_b64 exec, 1
    buffer_store_dword v18, v10, s[48:51], s40 offen sc1
    s_mov_b64 exec, -1
    s_add_u32 s42, s42, 196608
L_spn_o:
    s_mov_b64 exec, s[44:45]
    buffer_load_dword v28, v11, s[48:51], s42 offen sc1
    s_mov_b64 exec, -1
    s_branch L_sp_o
L_spo_o:
    buffer_load_dwordx4 v[128:131], v1, s[48:51], s70 offen offset:0 sc1
    buffer_load_dwordx4 v[132:135], v1, s[48:51], s70 offen offset:1024 sc1
    buffer_load_dwordx4 v[136:139], v1, s[48:51], s70 offen offset:2048 sc1
    buffer_load_dwordx4 v[140:143], v1, s[48:51], s70 offen offset:3072 sc1
    buffer_load_dwordx4 v[144:147], v1, s[48:51], s71 offen offset:0 sc1
    buffer_load_dwordx4 v[148:151], v1, s[48:51], s71 offen offset:1024 sc1
    buffer_load_dwordx4 v[152:155], v1, s[48:51], s71 offen offset:2048 sc1
    buffer_load_dwordx4 v[156:159], v1, s[48:51], s71 offen offset:3072 sc1
    s_waitcnt lgkmcnt(8)
    v_mfma_f32_16x16x32_bf16 v[80:83], a[0:3], v[208:211], v[80:83]
    ds_read_b64_tr_b16 a[24:25], v3 offset:27744
    v_mfma_f32_16x16x32_bf16 v[84:87], a[0:3], v[212:215], v[84:87]
    ds_read_b64_tr_b16 a[26:27], v3 offset:32352
    buffer_load_dwordx4 v[160:163], v1, s[48:51], s72 offen offset:0 sc1
    v_mfma_f32_16x16x32_bf16 v[88:91], a[4:7], v[208:211], v[88:91]
    ds_read_b64_tr_b16 a[28:29], v3 offset:27776
    v_mfma_f32_16x16x32_bf16 v[92:95], a[4:7], v[212:215], v[92:95]
    ds_read_b64_tr_b16 a[30:31], v3 offset:32384
    buffer_load_dwordx4 v[164:167], v1, s[48:51], s72 offen offset:1024 sc1
    s_waitcnt lgkmcnt(8)
    v_mfma_f32_16x16x32_bf16 v[96:99], a[8:11], v[208:211], v[96:99]
    ds_read_b64_tr_b16 a[0:1], v3 offset:27808
    v_mfma_f32_16x16x32_bf16 v[100:103], a[8:11], v[212:215], v[100:103]
    ds_read_b64_tr_b16 a[2:3], v3 offset:32416
    v_mfma_f32_16x16x32_bf16 v[32:35], a[12:15], v[216:219], v[32:35]
    ds_read_b64_tr_b16 a[4:5], v3 offset:27840
    v_mfma_f32_16x16x32_bf16 v[36:39], a[12:15], v[220:223], v[36:39]
    ds_read_b64_tr_b16 a[6:7], v3 offset:32448
    buffer_load_dwordx4 v[168:171], v1, s[48:51], s72 offen offset:2048 sc1
    s_waitcnt lgkmcnt(8)
    v_mfma_f32_16x16x32_bf16 v[40:43], a[16:19], v[216:219], v[40:43]
    ds_read_b64_tr_b16 a[8:9], v3 offset:27872
    v_mfma_f32_16x16x32_bf16 v[44:47], a[16:19], v[220:223], v[44:47]
    ds_read_b64_tr_b16 a[10:11], v3 offset:32480
    buffer_load_dwordx4 v[172:175], v1, s[48:51], s72 offen offset:3072 sc1
    v_mfma_f32_16x16x32_bf16 v[48:51], a[20:23], v[216:219], v[48:51]
    ds_read_b64_tr_b16 a[12:13], v3 offset:27904
    v_mfma_f32_16x16x32_bf16 v[52:55], a[20:23], v[220:223], v[52:55]
    ds_read_b64_tr_b16 a[14:15], v3 offset:32512
    s_waitcnt lgkmcnt(8)
    v_mfma_f32_16x16x32_bf16 v[56:59], a[24:27], v[216:219], v[56:59]
    ds_read_b64_tr_b16 a[16:17], v3 offset:36864
    v_mfma_f32_16x16x32_bf16 v[60:63], a[24:27], v[220:223], v[60:63]
    ds_read_b64_tr_b16 a[18:19], v3 offset:41472
    buffer_load_dwordx4 v[176:179], v1, s[48:51], s73 offen offset:0 sc1
    v_mfma_f32_16x16x32_bf16 v[64:67], a[28:31], v[216:219], v[64:67]
    ds_read_b64_tr_b16 a[20:21], v3 offset:36896
    v_mfma_f32_16x16x32_bf16 v[68:71], a[28:31], v[220:223], v[68:71]
    ds_read_b64_tr_b16 a[22:23], v3 offset:41504
    buffer_load_dwordx4 v[180:183], v1, s[48:51], s73 offen offset:1024 sc1
    s_waitcnt lgkmcnt(8)
    v_mfma_f32_16x16x32_bf16 v[72:75], a[0:3], v[216:219], v[72:75]
    ds_read_b64_tr_b16 a[24:25], v3 offset:36928
    v_mfma_f32_16x16x32_bf16 v[76:79], a[0:3], v[220:223], v[76:79]
    ds_read_b64_tr_b16 a[26:27], v3 offset:41536
    v_mfma_f32_16x16x32_bf16 v[80:83], a[4:7], v[216:219], v[80:83]
    ds_read_b64_tr_b16 a[28:29], v3 offset:36960
    v_mfma_f32_16x16x32_bf16 v[84:87], a[4:7], v[220:223], v[84:87]
    ds_read_b64_tr_b16 a[30:31], v3 offset:41568
    buffer_load_dwordx4 v[184:187], v1, s[48:51], s73 offen offset:2048 sc1
    s_waitcnt lgkmcnt(8)
    v_mfma_f32_16x16x32_bf16 v[88:91], a[8:11], v[216:219], v[88:91]
    ds_read_b64_tr_b16 a[0:1], v3 offset:46080
    v_mfma_f32_16x16x32_bf16 v[92:95], a[8:11], v[220:223], v[92:95]
    ds_read_b64_tr_b16 a[2:3], v3 offset:50688
    buffer_load_dwordx4 v[188:191], v1, s[48:51], s73 offen offset:3072 sc1
    v_mfma_f32_16x16x32_bf16 v[96:99], a[12:15], v[216:219], v[96:99]
    ds_read_b64_tr_b16 a[4:5], v3 offset:46112
    v_mfma_f32_16x16x32_bf16 v[100:103], a[12:15], v[220:223], v[100:103]
    ds_read_b64_tr_b16 a[6:7], v3 offset:50720
    s_waitcnt lgkmcnt(8)
    s_waitcnt vmcnt(15)
    v_mfma_f32_16x16x32_bf16 v[32:35], a[16:19], v[128:131], v[32:35]
    ds_read_b64_tr_b16 a[8:9], v3 offset:46144
    s_waitcnt vmcnt(14)
    v_mfma_f32_16x16x32_bf16 v[36:39], a[16:19], v[132:135], v[36:39]
    ds_read_b64_tr_b16 a[10:11], v3 offset:50752
    buffer_load_dwordx4 v[224:227], v1, s[48:51], s74 offen offset:0 sc1
    v_mfma_f32_16x16x32_bf16 v[40:43], a[20:23], v[128:131], v[40:43]
    ds_read_b64_tr_b16 a[12:13], v3 offset:46176
    v_mfma_f32_16x16x32_bf16 v[44:47], a[20:23], v[132:135], v[44:47]
    ds_read_b64_tr_b16 a[14:15], v3 offset:50784
    buffer_load_dwordx4 v[228:231], v1, s[48:51], s74 offen offset:1024 sc1
    s_waitcnt lgkmcnt(8)
    v_mfma_f32_16x16x32_bf16 v[48:51], a[24:27], v[128:131], v[48:51]
    ds_read_b64_tr_b16 a[16:17], v3 offset:55296
    v_mfma_f32_16x16x32_bf16 v[52:55], a[24:27], v[132:135], v[52:55]
    ds_read_b64_tr_b16 a[18:19], v3 offset:59904
    v_mfma_f32_16x16x32_bf16 v[56:59], a[28:31], v[128:131], v[56:59]
    ds_read_b64_tr_b16 a[20:21], v3 offset:55328
    v_mfma_f32_16x16x32_bf16 v[60:63], a[28:31], v[132:135], v[60:63]
    ds_read_b64_tr_b16 a[22:23], v3 offset:59936
    buffer_load_dwordx4 v[232:235], v1, s[48:51], s74 offen offset:2048 sc1
    s_waitcnt lgkmcnt(8)
    s_waitcnt vmcnt(16)
    v_mfma_f32_16x16x32_bf16 v[32:35], a[0:3], v[136:139], v[32:35]
    ds_read_b64_tr_b16 a[24:25], v3 offset:55360
    s_waitcnt vmcnt(15)
    v_mfma_f32_16x16x32_bf16 v[36:39], a[0:3], v[140:143], v[36:39]
    ds_read_b64_tr_b16 a[26:27], v3 offset:59968
    buffer_load_dwordx4 v[236:239], v1, s[48:51], s74 offen offset:3072 sc1
    v_mfma_f32_16x16x32_bf16 v[40:43], a[4:7], v[136:139], v[40:43]
    ds_read_b64_tr_b16 a[28:29], v3 offset:55392
    v_mfma_f32_16x16x32_bf16 v[44:47], a[4:7], v[140:143], v[44:47]
    ds_read_b64_tr_b16 a[30:31], v3 offset:60000
    s_waitcnt lgkmcnt(8)
    v_mfma_f32_16x16x32_bf16 v[48:51], a[8:11], v[136:139], v[48:51]
    ds_read_b64_tr_b16 a[0:1], v4 offset:0
    v_mfma_f32_16x16x32_bf16 v[52:55], a[8:11], v[140:143], v[52:55]
    ds_read_b64_tr_b16 a[2:3], v4 offset:4608
    buffer_load_dwordx4 v[240:243], v1, s[48:51], s75 offen offset:0 sc1
    v_mfma_f32_16x16x32_bf16 v[56:59], a[12:15], v[136:139], v[56:59]
    ds_read_b64_tr_b16 a[4:5], v4 offset:32
    v_mfma_f32_16x16x32_bf16 v[60:63], a[12:15], v[140:143], v[60:63]
    ds_read_b64_tr_b16 a[6:7], v4 offset:4640
    buffer_load_dwordx4 v[244:247], v1, s[48:51], s75 offen offset:1024 sc1
    s_waitcnt lgkmcnt(8)
    s_waitcnt vmcnt(17)
    v_mfma_f32_16x16x32_bf16 v[32:35], a[16:19], v[144:147], v[32:35]
    ds_read_b64_tr_b16 a[8:9], v4 offset:64
    s_waitcnt vmcnt(16)
    v_mfma_f32_16x16x32_bf16 v[36:39], a[16:19], v[148:151], v[36:39]
    ds_read_b64_tr_b16 a[10:11], v4 offset:4672
    v_mfma_f32_16x16x32_bf16 v[40:43], a[20:23], v[144:147], v[40:43]
    ds_read_b64_tr_b16 a[12:13], v4 offset:96
    v_mfma_f32_16x16x32_bf16 v[44:47], a[20:23], v[148:151], v[44:47]
    ds_read_b64_tr_b16 a[14:15], v4 offset:4704
    buffer_load_dwordx4 v[248:251], v1, s[48:51], s75 offen offset:2048 sc1
    s_waitcnt lgkmcnt(8)
    v_mfma_f32_16x16x32_bf16 v[48:51], a[24:27], v[144:147], v[48:51]
    ds_read_b64_tr_b16 a[16:17], v4 offset:9216
    v_mfma_f32_16x16x32_bf16 v[52:55], a[24:27], v[148:151], v[52:55]
    ds_read_b64_tr_b16 a[18:19], v4 offset:13824
    buffer_load_dwordx4 v[252:255], v1, s[48:51], s75 offen offset:3072 sc1
    v_mfma_f32_16x16x32_bf16 v[56:59], a[28:31], v[144:147], v[56:59]
    ds_read_b64_tr_b16 a[20:21], v4 offset:9248
    v_mfma_f32_16x16x32_bf16 v[60:63], a[28:31], v[148:151], v[60:63]
    ds_read_b64_tr_b16 a[22:23], v4 offset:13856
    s_waitcnt lgkmcnt(8)
    s_waitcnt vmcnt(17)
    v_mfma_f32_16x16x32_bf16 v[32:35], a[0:3], v[152:155], v[32:35]
    ds_read_b64_tr_b16 a[24:25], v4 offset:9280
    s_waitcnt vmcnt(16)
    v_mfma_f32_16x16x32_bf16 v[36:39], a[0:3], v[156:159], v[36:39]
    ds_read_b64_tr_b16 a[26:27], v4 offset:13888
    v_mfma_f32_16x16x32_bf16 v[40:43], a[4:7], v[152:155], v[40:43]
    ds_read_b64_tr_b16 a[28:29], v4 offset:18432
    v_mfma_f32_16x16x32_bf16 v[44:47], a[4:7], v[156:159], v[44:47]
    ds_read_b64_tr_b16 a[30:31], v4 offset:23040
    s_waitcnt lgkmcnt(8)
    v_mfma_f32_16x16x32_bf16 v[48:51], a[8:11], v[152:155], v[48:51]
    ds_read_b64_tr_b16 a[0:1], v4 offset:18464
    v_mfma_f32_16x16x32_bf16 v[52:55], a[8:11], v[156:159], v[52:55]
    ds_read_b64_tr_b16 a[2:3], v4 offset:23072
    v_mfma_f32_16x16x32_bf16 v[56:59], a[12:15], v[152:155], v[56:59]
    ds_read_b64_tr_b16 a[4:5], v4 offset:18496
    v_mfma_f32_16x16x32_bf16 v[60:63], a[12:15], v[156:159], v[60:63]
    ds_read_b64_tr_b16 a[6:7], v4 offset:23104
    s_waitcnt lgkmcnt(8)
    s_waitcnt vmcnt(15)
    v_mfma_f32_16x16x32_bf16 v[32:35], a[16:19], v[160:163], v[32:35]
    ds_read_b64_tr_b16 a[8:9], v4 offset:27648
    s_waitcnt vmcnt(14)
    v_mfma_f32_16x16x32_bf16 v[36:39], a[16:19], v[164:167], v[36:39]
    ds_read_b64_tr_b16 a[10:11], v4 offset:32256
    v_mfma_f32_16x16x32_bf16 v[40:43], a[20:23], v[160:163], v[40:43]
    ds_read_b64_tr_b16 a[12:13], v4 offset:27680
    v_mfma_f32_16x16x32_bf16 v[44:47], a[20:23], v[164:167], v[44:47]
    ds_read_b64_tr_b16 a[14:15], v4 offset:32288
    s_waitcnt lgkmcnt(8)
    v_mfma_f32_16x16x32_bf16 v[48:51], a[24:27], v[160:163], v[48:51]
    ds_read_b64_tr_b16 a[16:17], v4 offset:27712
    v_mfma_f32_16x16x32_bf16 v[52:55], a[24:27], v[164:167], v[52:55]
    ds_read_b64_tr_b16 a[18:19], v4 offset:32320
    s_waitcnt vmcnt(13)
    v_mfma_f32_16x16x32_bf16 v[32:35], a[28:31], v[168:171], v[32:35]
    ds_read_b64_tr_b16 a[20:21], v4 offset:36864
    s_waitcnt vmcnt(12)
    v_mfma_f32_16x16x32_bf16 v[36:39], a[28:31], v[172:175], v[36:39]
    ds_read_b64_tr_b16 a[22:23], v4 offset:41472
    s_waitcnt lgkmcnt(8)
    v_mfma_f32_16x16x32_bf16 v[40:43], a[0:3], v[168:171], v[40:43]
    ds_read_b64_tr_b16 a[24:25], v4 offset:36896
    s_nop 0
    v_mfma_f32_16x16x32_bf16 v[44:47], a[0:3], v[172:175], v[44:47]
    ds_read_b64_tr_b16 a[26:27], v4 offset:41504
    s_mov_b64 exec, 1
    buffer_store_dword v18, v10, s[48:51], s40 offen sc1
    s_mov_b64 exec, -1
    v_mfma_f32_16x16x32_bf16 v[48:51], a[4:7], v[168:171], v[48:51]
    ds_read_b64_tr_b16 a[28:29], v4 offset:36928
    v_mfma_f32_16x16x32_bf16 v[52:55], a[4:7], v[172:175], v[52:55]
    ds_read_b64_tr_b16 a[30:31], v4 offset:41536
    s_waitcnt lgkmcnt(8)
    s_waitcnt vmcnt(12)
    v_mfma_f32_16x16x32_bf16 v[32:35], a[8:11], v[176:179], v[32:35]
    ds_read_b64_tr_b16 a[0:1], v4 offset:46080
    s_waitcnt vmcnt(11)
    v_mfma_f32_16x16x32_bf16 v[36:39], a[8:11], v[180:183], v[36:39]
    ds_read_b64_tr_b16 a[2:3], v4 offset:50688
    v_mfma_f32_16x16x32_bf16 v[40:43], a[12:15], v[176:179], v[40:43]
    ds_read_b64_tr_b16 a[4:5], v4 offset:55296
    v_mfma_f32_16x16x32_bf16 v[44:47], a[12:15], v[180:183], v[44:47]
    ds_read_b64_tr_b16 a[6:7], v4 offset:59904
    s_waitcnt lgkmcnt(8)
    v_mfma_f32_16x16x32_bf16 v[48:51], a[16:19], v[176:179], v[48:51]
    ds_read_b64_tr_b16 a[8:9], v5 offset:0
    v_mfma_f32_16x16x32_bf16 v[52:55], a[16:19], v[180:183], v[52:55]
    ds_read_b64_tr_b16 a[10:11], v5 offset:4608
    s_waitcnt vmcnt(10)
    v_mfma_f32_16x16x32_bf16 v[32:35], a[20:23], v[184:187], v[32:35]
    ds_read_b64_tr_b16 a[12:13], v5 offset:9216
    s_waitcnt vmcnt(9)
    v_mfma_f32_16x16x32_bf16 v[36:39], a[20:23], v[188:191], v[36:39]
    ds_read_b64_tr_b16 a[14:15], v5 offset:13824
    s_waitcnt lgkmcnt(8)
    v_mfma_f32_16x16x32_bf16 v[40:43], a[24:27], v[184:187], v[40:43]
    ds_read_b64_tr_b16 a[16:17], v4 offset:46112
    v_mfma_f32_16x16x32_bf16 v[44:47], a[24:27], v[188:191], v[44:47]
    ds_read_b64_tr_b16 a[18:19], v4 offset:50720
    v_mfma_f32_16x16x32_bf16 v[48:51], a[28:31], v[184:187], v[48:51]
    ds_read_b64_tr_b16 a[20:21], v4 offset:55328
    v_mfma_f32_16x16x32_bf16 v[52:55], a[28:31], v[188:191], v[52:55]
    ds_read_b64_tr_b16 a[22:23], v4 offset:59936
    s_waitcnt lgkmcnt(8)
    s_waitcnt vmcnt(8)
    v_mfma_f32_16x16x32_bf16 v[32:35], a[0:3], v[224:227], v[32:35]
    ds_read_b64_tr_b16 a[24:25], v5 offset:32
    s_waitcnt vmcnt(7)
    v_mfma_f32_16x16x32_bf16 v[36:39], a[0:3], v[228:231], v[36:39]
    ds_read_b64_tr_b16 a[26:27], v5 offset:4640
    s_waitcnt vmcnt(6)
    v_mfma_f32_16x16x32_bf16 v[32:35], a[4:7], v[232:235], v[32:35]
    ds_read_b64_tr_b16 a[28:29], v5 offset:9248
    s_waitcnt vmcnt(5)
    v_mfma_f32_16x16x32_bf16 v[36:39], a[4:7], v[236:239], v[36:39]
    ds_read_b64_tr_b16 a[30:31], v5 offset:13856
    s_waitcnt lgkmcnt(8)
    s_waitcnt vmcnt(4)
    v_mfma_f32_16x16x32_bf16 v[32:35], a[8:11], v[240:243], v[32:35]
    ds_read_b64_tr_b16 a[0:1], v4 offset:46144
    s_waitcnt vmcnt(3)
    v_mfma_f32_16x16x32_bf16 v[36:39], a[8:11], v[244:247], v[36:39]
    ds_read_b64_tr_b16 a[2:3], v4 offset:50752
    s_waitcnt vmcnt(2)
    v_mfma_f32_16x16x32_bf16 v[32:35], a[12:15], v[248:251], v[32:35]
    ds_read_b64_tr_b16 a[4:5], v4 offset:55360
    s_waitcnt vmcnt(1)
    v_mfma_f32_16x16x32_bf16 v[36:39], a[12:15], v[252:255], v[36:39]
    ds_read_b64_tr_b16 a[6:7], v4 offset:59968
    s_waitcnt lgkmcnt(8)
    v_mfma_f32_16x16x32_bf16 v[40:43], a[16:19], v[224:227], v[40:43]
    ds_read_b64_tr_b16 a[8:9], v5 offset:64
    v_mfma_f32_16x16x32_bf16 v[44:47], a[16:19], v[228:231], v[44:47]
    ds_read_b64_tr_b16 a[10:11], v5 offset:4672
    v_mfma_f32_16x16x32_bf16 v[40:43], a[20:23], v[232:235], v[40:43]
    ds_read_b64_tr_b16 a[12:13], v5 offset:9280
    v_cvt_pk_bf16_f32 v32, v32, v33
    v_mfma_f32_16x16x32_bf16 v[44:47], a[20:23], v[236:239], v[44:47]
    ds_read_b64_tr_b16 a[14:15], v5 offset:13888
    v_cvt_pk_bf16_f32 v33, v34, v35
    s_waitcnt lgkmcnt(8)
    v_mfma_f32_16x16x32_bf16 v[40:43], a[24:27], v[240:243], v[40:43]
    ds_read_b64_tr_b16 a[16:17], v4 offset:9312
    v_cvt_pk_bf16_f32 v34, v36, v37
    v_mfma_f32_16x16x32_bf16 v[44:47], a[24:27], v[244:247], v[44:47]
    ds_read_b64_tr_b16 a[18:19], v4 offset:13920
    v_cvt_pk_bf16_f32 v35, v38, v39
    v_mfma_f32_16x16x32_bf16 v[40:43], a[28:31], v[248:251], v[40:43]
    ds_read_b64_tr_b16 a[20:21], v4 offset:18528
    v_mfma_f32_16x16x32_bf16 v[44:47], a[28:31], v[252:255], v[44:47]
    ds_read_b64_tr_b16 a[22:23], v4 offset:23136
    buffer_store_dwordx4 v[32:35], v1, s[48:51], s79 offen offset:0 sc1
    s_waitcnt lgkmcnt(8)
    v_mfma_f32_16x16x32_bf16 v[48:51], a[0:3], v[224:227], v[48:51]
    ds_read_b64_tr_b16 a[24:25], v4 offset:27744
    v_mfma_f32_16x16x32_bf16 v[52:55], a[0:3], v[228:231], v[52:55]
    ds_read_b64_tr_b16 a[26:27], v4 offset:32352
    v_mfma_f32_16x16x32_bf16 v[48:51], a[4:7], v[232:235], v[48:51]
    ds_read_b64_tr_b16 a[28:29], v4 offset:36960
    v_cvt_pk_bf16_f32 v40, v40, v41
    v_mfma_f32_16x16x32_bf16 v[52:55], a[4:7], v[236:239], v[52:55]
    ds_read_b64_tr_b16 a[30:31], v4 offset:41568
    v_cvt_pk_bf16_f32 v41, v42, v43
    s_waitcnt lgkmcnt(8)
    v_mfma_f32_16x16x32_bf16 v[48:51], a[8:11], v[240:243], v[48:51]
    ds_read_b64_tr_b16 a[0:1], v4 offset:46176
    v_cvt_pk_bf16_f32 v42, v44, v45
    v_mfma_f32_16x16x32_bf16 v[52:55], a[8:11], v[244:247], v[52:55]
    ds_read_b64_tr_b16 a[2:3], v4 offset:50784
    v_cvt_pk_bf16_f32 v43, v46, v47
    v_mfma_f32_16x16x32_bf16 v[48:51], a[12:15], v[248:251], v[48:51]
    ds_read_b64_tr_b16 a[4:5], v4 offset:55392
    v_mfma_f32_16x16x32_bf16 v[52:55], a[12:15], v[252:255], v[52:55]
    ds_read_b64_tr_b16 a[6:7], v4 offset:60000
    buffer_store_dwordx4 v[40:43], v1, s[48:51], s79 offen offset:1024 sc1
    s_waitcnt lgkmcnt(8)
    v_mfma_f32_16x16x32_bf16 v[56:59], a[16:19], v[160:163], v[56:59]
    ds_read_b64_tr_b16 a[8:9], v5 offset:96
    v_mfma_f32_16x16x32_bf16 v[60:63], a[16:19], v[164:167], v[60:63]
    ds_read_b64_tr_b16 a[10:11], v5 offset:4704
    v_mfma_f32_16x16x32_bf16 v[56:59], a[20:23], v[168:171], v[56:59]
    ds_read_b64_tr_b16 a[12:13], v5 offset:9312
    v_cvt_pk_bf16_f32 v48, v48, v49
    v_mfma_f32_16x16x32_bf16 v[60:63], a[20:23], v[172:175], v[60:63]
    ds_read_b64_tr_b16 a[14:15], v5 offset:13920
    v_cvt_pk_bf16_f32 v49, v50, v51
    s_waitcnt lgkmcnt(8)
    v_mfma_f32_16x16x32_bf16 v[56:59], a[24:27], v[176:179], v[56:59]
    ds_read_b64_tr_b16 a[16:17], v4 offset:9344
    v_cvt_pk_bf16_f32 v50, v52, v53
    v_mfma_f32_16x16x32_bf16 v[60:63], a[24:27], v[180:183], v[60:63]
    ds_read_b64_tr_b16 a[18:19], v4 offset:13952
    v_cvt_pk_bf16_f32 v51, v54, v55
    v_mfma_f32_16x16x32_bf16 v[56:59], a[28:31], v[184:187], v[56:59]
    ds_read_b64_tr_b16 a[20:21], v4 offset:18560
    v_mfma_f32_16x16x32_bf16 v[60:63], a[28:31], v[188:191], v[60:63]
    ds_read_b64_tr_b16 a[22:23], v4 offset:23168
    buffer_store_dwordx4 v[48:51], v1, s[48:51], s79 offen offset:2048 sc1
    s_waitcnt lgkmcnt(8)
    v_mfma_f32_16x16x32_bf16 v[56:59], a[0:3], v[224:227], v[56:59]
    ds_read_b64_tr_b16 a[24:25], v4 offset:27776
    v_mfma_f32_16x16x32_bf16 v[60:63], a[0:3], v[228:231], v[60:63]
    ds_read_b64_tr_b16 a[26:27], v4 offset:32384
    v_mfma_f32_16x16x32_bf16 v[56:59], a[4:7], v[232:235], v[56:59]
    ds_read_b64_tr_b16 a[28:29], v4 offset:36992
    v_mfma_f32_16x16x32_bf16 v[60:63], a[4:7], v[236:239], v[60:63]
    ds_read_b64_tr_b16 a[30:31], v4 offset:41600
    s_waitcnt lgkmcnt(8)
    v_mfma_f32_16x16x32_bf16 v[56:59], a[8:11], v[240:243], v[56:59]
    ds_read_b64_tr_b16 a[0:1], v4 offset:46208
    v_mfma_f32_16x16x32_bf16 v[60:63], a[8:11], v[244:247], v[60:63]
    ds_read_b64_tr_b16 a[2:3], v4 offset:50816
    v_mfma_f32_16x16x32_bf16 v[56:59], a[12:15], v[248:251], v[56:59]
    ds_read_b64_tr_b16 a[4:5], v4 offset:55424
    v_mfma_f32_16x16x32_bf16 v[60:63], a[12:15], v[252:255], v[60:63]
    ds_read_b64_tr_b16 a[6:7], v4 offset:60032
    s_waitcnt lgkmcnt(8)
    v_mfma_f32_16x16x32_bf16 v[64:67], a[16:19], v[160:163], v[64:67]
    ds_read_b64_tr_b16 a[8:9], v5 offset:128
    v_mfma_f32_16x16x32_bf16 v[68:71], a[16:19], v[164:167], v[68:71]
    ds_read_b64_tr_b16 a[10:11], v5 offset:4736
    v_mfma_f32_16x16x32_bf16 v[64:67], a[20:23], v[168:171], v[64:67]
    ds_read_b64_tr_b16 a[12:13], v5 offset:9344
    v_cvt_pk_bf16_f32 v56, v56, v57
    v_mfma_f32_16x16x32_bf16 v[68:71], a[20:23], v[172:175], v[68:71]
    ds_read_b64_tr_b16 a[14:15], v5 offset:13952
    v_cvt_pk_bf16_f32 v57, v58, v59
    s_waitcnt lgkmcnt(8)
    v_mfma_f32_16x16x32_bf16 v[64:67], a[24:27], v[176:179], v[64:67]
    ds_read_b64_tr_b16 a[16:17], v3 offset:36992
    v_cvt_pk_bf16_f32 v58, v60, v61
    v_mfma_f32_16x16x32_bf16 v[68:71], a[24:27], v[180:183], v[68:71]
    ds_read_b64_tr_b16 a[18:19], v3 offset:41600
    v_cvt_pk_bf16_f32 v59, v62, v63
    v_mfma_f32_16x16x32_bf16 v[64:67], a[28:31], v[184:187], v[64:67]
    ds_read_b64_tr_b16 a[20:21], v3 offset:46208
    buffer_store_dwordx4 v[56:59], v1, s[48:51], s79 offen offset:3072 sc1
    v_mfma_f32_16x16x32_bf16 v[68:71], a[28:31], v[188:191], v[68:71]
    ds_read_b64_tr_b16 a[22:23], v3 offset:50816
    s_add_u32 s79, s79, 4096
    s_waitcnt lgkmcnt(8)
    v_mfma_f32_16x16x32_bf16 v[64:67], a[0:3], v[224:227], v[64:67]
    ds_read_b64_tr_b16 a[24:25], v3 offset:55424
    v_mfma_f32_16x16x32_bf16 v[68:71], a[0:3], v[228:231], v[68:71]
    ds_read_b64_tr_b16 a[26:27], v3 offset:60032
    v_mfma_f32_16x16x32_bf16 v[64:67], a[4:7], v[232:235], v[64:67]
    ds_read_b64_tr_b16 a[28:29], v4 offset:128
    v_mfma_f32_16x16x32_bf16 v[68:71], a[4:7], v[236:239], v[68:71]
    ds_read_b64_tr_b16 a[30:31], v4 offset:4736
    s_waitcnt lgkmcnt(8)
    v_mfma_f32_16x16x32_bf16 v[64:67], a[8:11], v[240:243], v[64:67]
    ds_read_b64_tr_b16 a[0:1], v4 offset:9376
    v_mfma_f32_16x16x32_bf16 v[68:71], a[8:11], v[244:247], v[68:71]
    ds_read_b64_tr_b16 a[2:3], v4 offset:13984
    v_mfma_f32_16x16x32_bf16 v[64:67], a[12:15], v[248:251], v[64:67]
    ds_read_b64_tr_b16 a[4:5], v4 offset:18592
    v_mfma_f32_16x16x32_bf16 v[68:71], a[12:15], v[252:255], v[68:71]
    ds_read_b64_tr_b16 a[6:7], v4 offset:23200
    s_waitcnt lgkmcnt(8)
    v_mfma_f32_16x16x32_bf16 v[64:67], a[16:19], v[128:131], v[64:67]
    ds_read_b64_tr_b16 a[8:9], v4 offset:27808
    v_mfma_f32_16x16x32_bf16 v[68:71], a[16:19], v[132:135], v[68:71]
    ds_read_b64_tr_b16 a[10:11], v4 offset:32416
    v_mfma_f32_16x16x32_bf16 v[64:67], a[20:23], v[136:139], v[64:67]
    ds_read_b64_tr_b16 a[12:13], v4 offset:37024
    v_mfma_f32_16x16x32_bf16 v[68:71], a[20:23], v[140:143], v[68:71]
    ds_read_b64_tr_b16 a[14:15], v4 offset:41632
    s_waitcnt lgkmcnt(8)
    v_mfma_f32_16x16x32_bf16 v[64:67], a[24:27], v[144:147], v[64:67]
    ds_read_b64_tr_b16 a[16:17], v4 offset:46240
    v_mfma_f32_16x16x32_bf16 v[68:71], a[24:27], v[148:151], v[68:71]
    ds_read_b64_tr_b16 a[18:19], v4 offset:50848
    v_mfma_f32_16x16x32_bf16 v[64:67], a[28:31], v[152:155], v[64:67]
    ds_read_b64_tr_b16 a[20:21], v4 offset:55456
    v_mfma_f32_16x16x32_bf16 v[68:71], a[28:31], v[156:159], v[68:71]
    ds_read_b64_tr_b16 a[22:23], v4 offset:60064
    s_waitcnt lgkmcnt(8)
    v_mfma_f32_16x16x32_bf16 v[72:75], a[0:3], v[160:163], v[72:75]
    ds_read_b64_tr_b16 a[24:25], v5 offset:160
    v_mfma_f32_16x16x32_bf16 v[76:79], a[0:3], v[164:167], v[76:79]
    ds_read_b64_tr_b16 a[26:27], v5 offset:4768
    v_mfma_f32_16x16x32_bf16 v[72:75], a[4:7], v[168:171], v[72:75]
    ds_read_b64_tr_b16 a[28:29], v5 offset:9376
    v_cvt_pk_bf16_f32 v64, v64, v65
    v_mfma_f32_16x16x32_bf16 v[76:79], a[4:7], v[172:175], v[76:79]
    ds_read_b64_tr_b16 a[30:31], v5 offset:13984
    v_cvt_pk_bf16_f32 v65, v66, v67
    s_waitcnt lgkmcnt(8)
    v_mfma_f32_16x16x32_bf16 v[72:75], a[8:11], v[176:179], v[72:75]
    ds_read_b64_tr_b16 a[0:1], v3 offset:37024
    v_cvt_pk_bf16_f32 v66, v68, v69
    v_mfma_f32_16x16x32_bf16 v[76:79], a[8:11], v[180:183], v[76:79]
    ds_read_b64_tr_b16 a[2:3], v3 offset:41632
    v_cvt_pk_bf16_f32 v67, v70, v71
    v_mfma_f32_16x16x32_bf16 v[72:75], a[12:15], v[184:187], v[72:75]
    ds_read_b64_tr_b16 a[4:5], v3 offset:46240
    v_mfma_f32_16x16x32_bf16 v[76:79], a[12:15], v[188:191], v[76:79]
    ds_read_b64_tr_b16 a[6:7], v3 offset:50848
    buffer_store_dwordx4 v[64:67], v1, s[48:51], s79 offen offset:0 sc1
    s_waitcnt lgkmcnt(8)
    v_mfma_f32_16x16x32_bf16 v[72:75], a[16:19], v[224:227], v[72:75]
    ds_read_b64_tr_b16 a[8:9], v3 offset:55456
    v_mfma_f32_16x16x32_bf16 v[76:79], a[16:19], v[228:231], v[76:79]
    ds_read_b64_tr_b16 a[10:11], v3 offset:60064
    v_mfma_f32_16x16x32_bf16 v[72:75], a[20:23], v[232:235], v[72:75]
    ds_read_b64_tr_b16 a[12:13], v4 offset:160
    v_mfma_f32_16x16x32_bf16 v[76:79], a[20:23], v[236:239], v[76:79]
    ds_read_b64_tr_b16 a[14:15], v4 offset:4768
    s_waitcnt lgkmcnt(8)
    v_mfma_f32_16x16x32_bf16 v[72:75], a[24:27], v[240:243], v[72:75]
    ds_read_b64_tr_b16 a[16:17], v4 offset:9408
    v_mfma_f32_16x16x32_bf16 v[76:79], a[24:27], v[244:247], v[76:79]
    ds_read_b64_tr_b16 a[18:19], v4 offset:14016
    v_mfma_f32_16x16x32_bf16 v[72:75], a[28:31], v[248:251], v[72:75]
    ds_read_b64_tr_b16 a[20:21], v4 offset:18624
    v_mfma_f32_16x16x32_bf16 v[76:79], a[28:31], v[252:255], v[76:79]
    ds_read_b64_tr_b16 a[22:23], v4 offset:23232
    s_waitcnt lgkmcnt(8)
    v_mfma_f32_16x16x32_bf16 v[72:75], a[0:3], v[128:131], v[72:75]
    ds_read_b64_tr_b16 a[24:25], v4 offset:27840
    v_mfma_f32_16x16x32_bf16 v[76:79], a[0:3], v[132:135], v[76:79]
    ds_read_b64_tr_b16 a[26:27], v4 offset:32448
    v_mfma_f32_16x16x32_bf16 v[72:75], a[4:7], v[136:139], v[72:75]
    ds_read_b64_tr_b16 a[28:29], v4 offset:37056
    v_mfma_f32_16x16x32_bf16 v[76:79], a[4:7], v[140:143], v[76:79]
    ds_read_b64_tr_b16 a[30:31], v4 offset:41664
    s_waitcnt lgkmcnt(8)
    v_mfma_f32_16x16x32_bf16 v[72:75], a[8:11], v[144:147], v[72:75]
    ds_read_b64_tr_b16 a[0:1], v4 offset:46272
    v_mfma_f32_16x16x32_bf16 v[76:79], a[8:11], v[148:151], v[76:79]
    ds_read_b64_tr_b16 a[2:3], v4 offset:50880
    v_mfma_f32_16x16x32_bf16 v[72:75], a[12:15], v[152:155], v[72:75]
    ds_read_b64_tr_b16 a[4:5], v4 offset:55488
    v_mfma_f32_16x16x32_bf16 v[76:79], a[12:15], v[156:159], v[76:79]
    ds_read_b64_tr_b16 a[6:7], v4 offset:60096
    s_waitcnt lgkmcnt(8)
    v_mfma_f32_16x16x32_bf16 v[80:83], a[16:19], v[160:163], v[80:83]
    ds_read_b64_tr_b16 a[8:9], v5 offset:192
    v_mfma_f32_16x16x32_bf16 v[84:87], a[16:19], v[164:167], v[84:87]
    ds_read_b64_tr_b16 a[10:11], v5 offset:4800
    buffer_load_dwordx4 v[192:195], v8, s[48:51], s78 offen sc1
    v_mfma_f32_16x16x32_bf16 v[80:83], a[20:23], v[168:171], v[80:83]
    ds_read_b64_tr_b16 a[12:13], v5 offset:9408
    v_cvt_pk_bf16_f32 v72, v72, v73
    v_mfma_f32_16x16x32_bf16 v[84:87], a[20:23], v[172:175], v[84:87]
    ds_read_b64_tr_b16 a[14:15], v5 offset:14016
    v_cvt_pk_bf16_f32 v73, v74, v75
    s_waitcnt lgkmcnt(8)
    v_mfma_f32_16x16x32_bf16 v[80:83], a[24:27], v[176:179], v[80:83]
    ds_read_b64_tr_b16 a[16:17], v3 offset:37056
    v_cvt_pk_bf16_f32 v74, v76, v77
    v_mfma_f32_16x16x32_bf16 v[84:87], a[24:27], v[180:183], v[84:87]
    ds_read_b64_tr_b16 a[18:19], v3 offset:41664
    v_cvt_pk_bf16_f32 v75, v78, v79
    v_mfma_f32_16x16x32_bf16 v[80:83], a[28:31], v[184:187], v[80:83]
    ds_read_b64_tr_b16 a[20:21], v3 offset:46272
    v_mfma_f32_16x16x32_bf16 v[84:87], a[28:31], v[188:191], v[84:87]
    ds_read_b64_tr_b16 a[22:23], v3 offset:50880
    buffer_store_dwordx4 v[72:75], v1, s[48:51], s79 offen offset:1024 sc1
    s_waitcnt lgkmcnt(8)
    v_mfma_f32_16x16x32_bf16 v[80:83], a[0:3], v[224:227], v[80:83]
    ds_read_b64_tr_b16 a[24:25], v3 offset:55488
    v_mfma_f32_16x16x32_bf16 v[84:87], a[0:3], v[228:231], v[84:87]
    ds_read_b64_tr_b16 a[26:27], v3 offset:60096
    buffer_load_dwordx4 v[196:199], v1, s[48:51], s81 offen sc1
    v_mfma_f32_16x16x32_bf16 v[80:83], a[4:7], v[232:235], v[80:83]
    ds_read_b64_tr_b16 a[28:29], v4 offset:192
    v_mfma_f32_16x16x32_bf16 v[84:87], a[4:7], v[236:239], v[84:87]
    ds_read_b64_tr_b16 a[30:31], v4 offset:4800
    s_waitcnt lgkmcnt(8)
    v_mfma_f32_16x16x32_bf16 v[80:83], a[8:11], v[240:243], v[80:83]
    ds_read_b64_tr_b16 a[0:1], v4 offset:9440
    v_mfma_f32_16x16x32_bf16 v[84:87], a[8:11], v[244:247], v[84:87]
    ds_read_b64_tr_b16 a[2:3], v4 offset:14048
    v_mfma_f32_16x16x32_bf16 v[80:83], a[12:15], v[248:251], v[80:83]
    ds_read_b64_tr_b16 a[4:5], v4 offset:18656
    v_mfma_f32_16x16x32_bf16 v[84:87], a[12:15], v[252:255], v[84:87]
    ds_read_b64_tr_b16 a[6:7], v4 offset:23264
    s_waitcnt lgkmcnt(8)
    v_mfma_f32_16x16x32_bf16 v[80:83], a[16:19], v[128:131], v[80:83]
    ds_read_b64_tr_b16 a[8:9], v4 offset:27872
    v_mfma_f32_16x16x32_bf16 v[84:87], a[16:19], v[132:135], v[84:87]
    ds_read_b64_tr_b16 a[10:11], v4 offset:32480
    buffer_load_dwordx4 v[200:203], v1, s[48:51], s82 offen sc1
    v_mfma_f32_16x16x32_bf16 v[80:83], a[20:23], v[136:139], v[80:83]
    ds_read_b64_tr_b16 a[12:13], v4 offset:37088
    v_mfma_f32_16x16x32_bf16 v[84:87], a[20:23], v[140:143], v[84:87]
    ds_read_b64_tr_b16 a[14:15], v4 offset:41696
    s_waitcnt lgkmcnt(8)
    v_mfma_f32_16x16x32_bf16 v[80:83], a[24:27], v[144:147], v[80:83]
    ds_read_b64_tr_b16 a[16:17], v4 offset:46304
    v_mfma_f32_16x16x32_bf16 v[84:87], a[24:27], v[148:151], v[84:87]
    ds_read_b64_tr_b16 a[18:19], v4 offset:50912
    v_mfma_f32_16x16x32_bf16 v[80:83], a[28:31], v[152:155], v[80:83]
    ds_read_b64_tr_b16 a[20:21], v4 offset:55520
    v_mfma_f32_16x16x32_bf16 v[84:87], a[28:31], v[156:159], v[84:87]
    ds_read_b64_tr_b16 a[22:23], v4 offset:60128
    s_waitcnt lgkmcnt(8)
    v_mfma_f32_16x16x32_bf16 v[88:91], a[0:3], v[160:163], v[88:91]
    ds_read_b64_tr_b16 a[24:25], v5 offset:224
    v_mfma_f32_16x16x32_bf16 v[92:95], a[0:3], v[164:167], v[92:95]
    ds_read_b64_tr_b16 a[26:27], v5 offset:4832
    buffer_load_dwordx4 v[204:207], v1, s[48:51], s83 offen sc1
    v_mfma_f32_16x16x32_bf16 v[88:91], a[4:7], v[168:171], v[88:91]
    ds_read_b64_tr_b16 a[28:29], v5 offset:9440
    v_cvt_pk_bf16_f32 v80, v80, v81
    v_mfma_f32_16x16x32_bf16 v[92:95], a[4:7], v[172:175], v[92:95]
    ds_read_b64_tr_b16 a[30:31], v5 offset:14048
    v_cvt_pk_bf16_f32 v81, v82, v83
    s_waitcnt lgkmcnt(8)
    v_mfma_f32_16x16x32_bf16 v[88:91], a[8:11], v[176:179], v[88:91]
    ds_read_b64_tr_b16 a[0:1], v3 offset:37088
    v_cvt_pk_bf16_f32 v82, v84, v85
    v_mfma_f32_16x16x32_bf16 v[92:95], a[8:11], v[180:183], v[92:95]
    ds_read_b64_tr_b16 a[2:3], v3 offset:41696
    v_cvt_pk_bf16_f32 v83, v86, v87
    v_mfma_f32_16x16x32_bf16 v[88:91], a[12:15], v[184:187], v[88:91]
    ds_read_b64_tr_b16 a[4:5], v3 offset:46304
    v_mfma_f32_16x16x32_bf16 v[92:95], a[12:15], v[188:191], v[92:95]
    ds_read_b64_tr_b16 a[6:7], v3 offset:50912
    buffer_store_dwordx4 v[80:83], v1, s[48:51], s79 offen offset:2048 sc1
    s_waitcnt lgkmcnt(8)
    v_mfma_f32_16x16x32_bf16 v[88:91], a[16:19], v[224:227], v[88:91]
    ds_read_b64_tr_b16 a[8:9], v3 offset:55520
    v_mfma_f32_16x16x32_bf16 v[92:95], a[16:19], v[228:231], v[92:95]
    ds_read_b64_tr_b16 a[10:11], v3 offset:60128
    v_mfma_f32_16x16x32_bf16 v[88:91], a[20:23], v[232:235], v[88:91]
    ds_read_b64_tr_b16 a[12:13], v4 offset:224
    v_mfma_f32_16x16x32_bf16 v[92:95], a[20:23], v[236:239], v[92:95]
    ds_read_b64_tr_b16 a[14:15], v4 offset:4832
    s_waitcnt lgkmcnt(8)
    v_mfma_f32_16x16x32_bf16 v[88:91], a[24:27], v[240:243], v[88:91]
    ds_read_b64_tr_b16 a[16:17], v4 offset:9472
    v_mfma_f32_16x16x32_bf16 v[92:95], a[24:27], v[244:247], v[92:95]
    ds_read_b64_tr_b16 a[18:19], v4 offset:14080
    v_mfma_f32_16x16x32_bf16 v[88:91], a[28:31], v[248:251], v[88:91]
    ds_read_b64_tr_b16 a[20:21], v4 offset:18688
    v_mfma_f32_16x16x32_bf16 v[92:95], a[28:31], v[252:255], v[92:95]
    ds_read_b64_tr_b16 a[22:23], v4 offset:23296
    s_waitcnt lgkmcnt(8)
    v_mfma_f32_16x16x32_bf16 v[88:91], a[0:3], v[128:131], v[88:91]
    ds_read_b64_tr_b16 a[24:25], v4 offset:27904
    v_mfma_f32_16x16x32_bf16 v[92:95], a[0:3], v[132:135], v[92:95]
    ds_read_b64_tr_b16 a[26:27], v4 offset:32512
    v_mfma_f32_16x16x32_bf16 v[88:91], a[4:7], v[136:139], v[88:91]
    ds_read_b64_tr_b16 a[28:29], v4 offset:37120
    v_mfma_f32_16x16x32_bf16 v[92:95], a[4:7], v[140:143], v[92:95]
    ds_read_b64_tr_b16 a[30:31], v4 offset:41728
    s_waitcnt lgkmcnt(8)
    v_mfma_f32_16x16x32_bf16 v[88:91], a[8:11], v[144:147], v[88:91]
    ds_read_b64_tr_b16 a[0:1], v4 offset:46336
    v_mfma_f32_16x16x32_bf16 v[92:95], a[8:11], v[148:151], v[92:95]
    ds_read_b64_tr_b16 a[2:3], v4 offset:50944
    v_mfma_f32_16x16x32_bf16 v[88:91], a[12:15], v[152:155], v[88:91]
    ds_read_b64_tr_b16 a[4:5], v4 offset:55552
    v_mfma_f32_16x16x32_bf16 v[92:95], a[12:15], v[156:159], v[92:95]
    ds_read_b64_tr_b16 a[6:7], v4 offset:60160
    s_waitcnt lgkmcnt(8)
    v_mfma_f32_16x16x32_bf16 v[96:99], a[16:19], v[160:163], v[96:99]
    ds_read_b64_tr_b16 a[8:9], v5 offset:256
    v_mfma_f32_16x16x32_bf16 v[100:103], a[16:19], v[164:167], v[100:103]
    ds_read_b64_tr_b16 a[10:11], v5 offset:4864
    v_mfma_f32_16x16x32_bf16 v[96:99], a[20:23], v[168:171], v[96:99]
    ds_read_b64_tr_b16 a[12:13], v5 offset:9472
    v_cvt_pk_bf16_f32 v88, v88, v89
    v_mfma_f32_16x16x32_bf16 v[100:103], a[20:23], v[172:175], v[100:103]
    ds_read_b64_tr_b16 a[14:15], v5 offset:14080
    v_cvt_pk_bf16_f32 v89, v90, v91
    s_waitcnt lgkmcnt(8)
    v_mfma_f32_16x16x32_bf16 v[96:99], a[24:27], v[176:179], v[96:99]
    ds_read_b64_tr_b16 a[16:17], v3 offset:37120
    v_cvt_pk_bf16_f32 v90, v92, v93
    v_mfma_f32_16x16x32_bf16 v[100:103], a[24:27], v[180:183], v[100:103]
    ds_read_b64_tr_b16 a[18:19], v3 offset:41728
    v_cvt_pk_bf16_f32 v91, v94, v95
    v_mfma_f32_16x16x32_bf16 v[96:99], a[28:31], v[184:187], v[96:99]
    ds_read_b64_tr_b16 a[20:21], v3 offset:46336
    buffer_store_dwordx4 v[88:91], v1, s[48:51], s79 offen offset:3072 sc1
    v_mfma_f32_16x16x32_bf16 v[100:103], a[28:31], v[188:191], v[100:103]
    ds_read_b64_tr_b16 a[22:23], v3 offset:50944
    s_add_u32 s79, s79, 4096
    s_waitcnt lgkmcnt(8)
    v_mfma_f32_16x16x32_bf16 v[96:99], a[0:3], v[224:227], v[96:99]
    ds_read_b64_tr_b16 a[24:25], v3 offset:55552
    v_mfma_f32_16x16x32_bf16 v[100:103], a[0:3], v[228:231], v[100:103]
    ds_read_b64_tr_b16 a[26:27], v3 offset:60160
    v_mfma_f32_16x16x32_bf16 v[96:99], a[4:7], v[232:235], v[96:99]
    ds_read_b64_tr_b16 a[28:29], v4 offset:256
    v_mfma_f32_16x16x32_bf16 v[100:103], a[4:7], v[236:239], v[100:103]
    ds_read_b64_tr_b16 a[30:31], v4 offset:4864
    s_waitcnt lgkmcnt(8)
    v_mfma_f32_16x16x32_bf16 v[96:99], a[8:11], v[240:243], v[96:99]
    v_mfma_f32_16x16x32_bf16 v[100:103], a[8:11], v[244:247], v[100:103]
    v_mfma_f32_16x16x32_bf16 v[96:99], a[12:15], v[248:251], v[96:99]
    v_mfma_f32_16x16x32_bf16 v[100:103], a[12:15], v[252:255], v[100:103]
    s_waitcnt lgkmcnt(4)
    v_mfma_f32_16x16x32_bf16 v[96:99], a[16:19], v[128:131], v[96:99]
    v_mfma_f32_16x16x32_bf16 v[100:103], a[16:19], v[132:135], v[100:103]
    v_mfma_f32_16x16x32_bf16 v[96:99], a[20:23], v[136:139], v[96:99]
    v_mfma_f32_16x16x32_bf16 v[100:103], a[20:23], v[140:143], v[100:103]
    s_waitcnt lgkmcnt(0)
    v_mfma_f32_16x16x32_bf16 v[96:99], a[24:27], v[144:147], v[96:99]
    v_mfma_f32_16x16x32_bf16 v[100:103], a[24:27], v[148:151], v[100:103]
    v_mfma_f32_16x16x32_bf16 v[96:99], a[28:31], v[152:155], v[96:99]
    v_mfma_f32_16x16x32_bf16 v[100:103], a[28:31], v[156:159], v[100:103]
    s_mov_b32 s60, 0
    buffer_load_dwordx4 v[208:211], v1, s[48:51], s84 offen sc1
    buffer_load_dwordx4 v[212:215], v1, s[48:51], s85 offen sc1
    buffer_load_dwordx4 v[216:219], v1, s[48:51], s86 offen sc1
    buffer_load_dwordx4 v[220:223], v1, s[48:51], s87 offen sc1
L_hc0:
    s_waitcnt vmcnt(7)
    v_max3_u32 v18, v192, v193, v194
    v_max_u32 v18, v18, v195
    v_cmp_eq_u32 vcc, -1, v18
    s_cbranch_vccnz L_hr0
L_hk0:
    v_lshlrev_b32 v104, 16, v192
    v_and_b32 v105, s63, v192
    v_lshlrev_b32 v106, 16, v193
    v_and_b32 v107, s63, v193
    v_lshlrev_b32 v108, 16, v194
    v_and_b32 v109, s63, v194
    v_lshlrev_b32 v110, 16, v195
    v_and_b32 v111, s63, v195
    v_permlane32_swap_b32 v104, v108
    v_permlane32_swap_b32 v105, v109
    v_permlane32_swap_b32 v106, v110
    v_permlane32_swap_b32 v107, v111
    v_pk_add_f32 v[104:105], v[104:105], v[108:109]
    v_pk_add_f32 v[106:107], v[106:107], v[110:111]
    s_nop 1
    v_permlane16_swap_b32 v104, v106
    v_permlane16_swap_b32 v105, v107
    v_pk_add_f32 v[104:105], v[104:105], v[106:107]
    s_nop 1
    v_add_f32_dpp v104, v104, v104 row_ror:8 row_mask:0xf bank_mask:0xf
    v_add_f32_dpp v105, v105, v105 row_ror:8 row_mask:0xf bank_mask:0xf
    v_cvt_pk_bf16_f32 v104, v104, v105
L_hc1:
    s_waitcnt vmcnt(6)
    v_max3_u32 v18, v196, v197, v198
    v_max_u32 v18, v18, v199
    v_cmp_eq_u32 vcc, -1, v18
    s_cbranch_vccnz L_hr1
L_hk1:
    v_mfma_f32_16x16x32_bf16 v[96:99], a[138:141], v[196:199], v[96:99]
    v_mfma_f32_16x16x32_bf16 v[100:103], a[136:139], v[196:199], v[100:103]
L_hc2:
    s_waitcnt vmcnt(5)
    v_max3_u32 v18, v200, v201, v202
    v_max_u32 v18, v18, v203
    v_cmp_eq_u32 vcc, -1, v18
    s_cbranch_vccnz L_hr2
L_hk2:
    v_mfma_f32_16x16x32_bf16 v[96:99], a[138:141], v[200:203], v[96:99]
    v_mfma_f32_16x16x32_bf16 v[100:103], a[136:139], v[200:203], v[100:103]
L_hc3:
    s_waitcnt vmcnt(4)
    v_max3_u32 v18, v204, v205, v206
    v_max_u32 v18, v18, v207
    v_cmp_eq_u32 vcc, -1, v18
    s_cbranch_vccnz L_hr3
L_hk3:
    v_mfma_f32_16x16x32_bf16 v[96:99], a[138:141], v[204:207], v[96:99]
    v_mfma_f32_16x16x32_bf16 v[100:103], a[136:139], v[204:207], v[100:103]
L_hc4:
    s_waitcnt vmcnt(3)
    v_max3_u32 v18, v208, v209, v210
    v_max_u32 v18, v18, v211
    v_cmp_eq_u32 vcc, -1, v18
    s_cbranch_vccnz L_hr4
L_hk4:
    v_mfma_f32_16x16x32_bf16 v[96:99], a[138:141], v[208:211], v[96:99]
    v_mfma_f32_16x16x32_bf16 v[100:103], a[136:139], v[208:211], v[100:103]
L_hc5:
    s_waitcnt vmcnt(2)
    v_max3_u32 v18, v212, v213, v214
    v_max_u32 v18, v18, v215
    v_cmp_eq_u32 vcc, -1, v18
    s_cbranch_vccnz L_hr5
L_hk5:
    v_mfma_f32_16x16x32_bf16 v[96:99], a[138:141], v[212:215], v[96:99]
    v_mfma_f32_16x16x32_bf16 v[100:103], a[136:139], v[212:215], v[100:103]
L_hc6:
    s_waitcnt vmcnt(1)
    v_max3_u32 v18, v216, v217, v218
    v_max_u32 v18, v18, v219
    v_cmp_eq_u32 vcc, -1, v18
    s_cbranch_vccnz L_hr6
L_hk6:
    v_mfma_f32_16x16x32_bf16 v[96:99], a[138:141], v[216:219], v[96:99]
    v_mfma_f32_16x16x32_bf16 v[100:103], a[136:139], v[216:219], v[100:103]
L_hc7:
    s_waitcnt vmcnt(0)
    v_max3_u32 v18, v220, v221, v222
    v_max_u32 v18, v18, v223
    v_cmp_eq_u32 vcc, -1, v18
    s_cbranch_vccnz L_hr7
L_hk7:
    v_mfma_f32_16x16x32_bf16 v[96:99], a[138:141], v[220:223], v[96:99]
    v_mfma_f32_16x16x32_bf16 v[100:103], a[136:139], v[220:223], v[100:103]
L_fin:
    s_nop 6
    v_cvt_pk_bf16_f32 v96, v96, v97
    v_cvt_pk_bf16_f32 v97, v98, v99
    v_cvt_pk_bf16_f32 v98, v100, v101
    v_cvt_pk_bf16_f32 v99, v102, v103
    buffer_store_dwordx2 v[96:97], v6, s[32:35], s54 offen
    buffer_store_dwordx2 v[98:99], v6, s[32:35], s52 offen
    s_mov_b32 exec_lo, 0x00ff00ff
    s_mov_b32 exec_hi, 0x00ff00ff
    buffer_store_dword v104, v7, s[32:35], s54 offen offset:256
    s_add_u32 s25, s25, 1
L_end:
    s_endpgm
L_hr7:
    s_add_u32 s60, s60, 1
    s_cmp_gt_u32 s60, 40000
    s_cbranch_scc1 L_hk7
    buffer_load_dwordx4 v[220:223], v1, s[48:51], s87 offen sc1
    s_branch L_hc7
L_hr6:
    s_add_u32 s60, s60, 1
    s_cmp_gt_u32 s60, 40000
    s_cbranch_scc1 L_hk6
    buffer_load_dwordx4 v[216:219], v1, s[48:51], s86 offen sc1
    buffer_load_dwordx4 v[220:223], v1, s[48:51], s87 offen sc1
    s_branch L_hc6
L_hr5:
    s_add_u32 s60, s60, 1
    s_cmp_gt_u32 s60, 40000
    s_cbranch_scc1 L_hk5
    buffer_load_dwordx4 v[212:215], v1, s[48:51], s85 offen sc1
    buffer_load_dwordx4 v[216:219], v1, s[48:51], s86 offen sc1
    buffer_load_dwordx4 v[220:223], v1, s[48:51], s87 offen sc1
    s_branch L_hc5
L_hr4:
    s_add_u32 s60, s60, 1
    s_cmp_gt_u32 s60, 40000
    s_cbranch_scc1 L_hk4
    buffer_load_dwordx4 v[208:211], v1, s[48:51], s84 offen sc1
    buffer_load_dwordx4 v[212:215], v1, s[48:51], s85 offen sc1
    buffer_load_dwordx4 v[216:219], v1, s[48:51], s86 offen sc1
    buffer_load_dwordx4 v[220:223], v1, s[48:51], s87 offen sc1
    s_branch L_hc4
L_hr3:
    s_add_u32 s60, s60, 1
    s_cmp_gt_u32 s60, 40000
    s_cbranch_scc1 L_hk3
    buffer_load_dwordx4 v[204:207], v1, s[48:51], s83 offen sc1
    buffer_load_dwordx4 v[208:211], v1, s[48:51], s84 offen sc1
    buffer_load_dwordx4 v[212:215], v1, s[48:51], s85 offen sc1
    buffer_load_dwordx4 v[216:219], v1, s[48:51], s86 offen sc1
    buffer_load_dwordx4 v[220:223], v1, s[48:51], s87 offen sc1
    s_branch L_hc3
L_hr2:
    s_add_u32 s60, s60, 1
    s_cmp_gt_u32 s60, 40000
    s_cbranch_scc1 L_hk2
    buffer_load_dwordx4 v[200:203], v1, s[48:51], s82 offen sc1
    buffer_load_dwordx4 v[204:207], v1, s[48:51], s83 offen sc1
    buffer_load_dwordx4 v[208:211], v1, s[48:51], s84 offen sc1
    buffer_load_dwordx4 v[212:215], v1, s[48:51], s85 offen sc1
    buffer_load_dwordx4 v[216:219], v1, s[48:51], s86 offen sc1
    buffer_load_dwordx4 v[220:223], v1, s[48:51], s87 offen sc1
    s_branch L_hc2
L_hr1:
    s_add_u32 s60, s60, 1
    s_cmp_gt_u32 s60, 40000
    s_cbranch_scc1 L_hk1
    buffer_load_dwordx4 v[196:199], v1, s[48:51], s81 offen sc1
    buffer_load_dwordx4 v[200:203], v1, s[48:51], s82 offen sc1
    buffer_load_dwordx4 v[204:207], v1, s[48:51], s83 offen sc1
    buffer_load_dwordx4 v[208:211], v1, s[48:51], s84 offen sc1
    buffer_load_dwordx4 v[212:215], v1, s[48:51], s85 offen sc1
    buffer_load_dwordx4 v[216:219], v1, s[48:51], s86 offen sc1
    buffer_load_dwordx4 v[220:223], v1, s[48:51], s87 offen sc1
    s_branch L_hc1
L_hr0:
    s_add_u32 s60, s60, 1
    s_cmp_gt_u32 s60, 40000
    s_cbranch_scc1 L_hk0
    buffer_load_dwordx4 v[192:195], v8, s[48:51], s78 offen sc1
    buffer_load_dwordx4 v[196:199], v1, s[48:51], s81 offen sc1
    buffer_load_dwordx4 v[200:203], v1, s[48:51], s82 offen sc1
    buffer_load_dwordx4 v[204:207], v1, s[48:51], s83 offen sc1
    buffer_load_dwordx4 v[208:211], v1, s[48:51], s84 offen sc1
    buffer_load_dwordx4 v[212:215], v1, s[48:51], s85 offen sc1
    buffer_load_dwordx4 v[216:219], v1, s[48:51], s86 offen sc1
    buffer_load_dwordx4 v[220:223], v1, s[48:51], s87 offen sc1
    s_branch L_hc0
L_slow_a:
    s_nop 15
    v_max3_f32 v18, v64, v65, v66
    v_max3_f32 v19, v67, v68, v69
    v_max3_f32 v18, v70, v71, v18
    v_max3_f32 v19, v72, v73, v19
    v_max3_f32 v18, v74, v75, v18
    v_max3_f32 v19, v76, v77, v19
    v_max3_f32 v18, v78, v79, v18
    v_max_f32 v18, v18, v19
    v_mov_b32 v19, v18
    s_nop 1
    v_permlane32_swap_b32 v18, v19
    v_max_f32 v18, v18, v19
    v_add_f32 v18, 0x40e00000, v18
    v_max_f32 v18, 0, v18
    v_exp_f32 v19, -v18
    v_sub_f32 v112, v112, v18
    v_sub_f32 v113, v113, v18
    v_sub_f32 v114, v114, v18
    v_sub_f32 v115, v115, v18
    v_sub_f32 v116, v116, v18
    v_sub_f32 v117, v117, v18
    v_sub_f32 v118, v118, v18
    v_sub_f32 v119, v119, v18
    v_sub_f32 v120, v120, v18
    v_sub_f32 v121, v121, v18
    v_sub_f32 v122, v122, v18
    v_sub_f32 v123, v123, v18
    v_sub_f32 v124, v124, v18
    v_sub_f32 v125, v125, v18
    v_sub_f32 v126, v126, v18
    v_sub_f32 v127, v127, v18
    v_sub_f32 v64, v64, v18
    v_sub_f32 v65, v65, v18
    v_sub_f32 v66, v66, v18
    v_sub_f32 v67, v67, v18
    v_sub_f32 v68, v68, v18
    v_sub_f32 v69, v69, v18
    v_sub_f32 v70, v70, v18
    v_sub_f32 v71, v71, v18
    v_sub_f32 v72, v72, v18
    v_sub_f32 v73, v73, v18
    v_sub_f32 v74, v74, v18
    v_sub_f32 v75, v75, v18
    v_sub_f32 v76, v76, v18
    v_sub_f32 v77, v77, v18
    v_sub_f32 v78, v78, v18
    v_sub_f32 v79, v79, v18
    v_sub_f32 v80, v80, v18
    v_sub_f32 v81, v81, v18
    v_sub_f32 v82, v82, v18
    v_sub_f32 v83, v83, v18
    v_sub_f32 v84, v84, v18
    v_sub_f32 v85, v85, v18
    v_sub_f32 v86, v86, v18
    v_sub_f32 v87, v87, v18
    v_sub_f32 v88, v88, v18
    v_sub_f32 v89, v89, v18
    v_sub_f32 v90, v90, v18
    v_sub_f32 v91, v91, v18
    v_sub_f32 v92, v92, v18
    v_sub_f32 v93, v93, v18
    v_sub_f32 v94, v94, v18
    v_sub_f32 v95, v95, v18
    v_mul_f32 v22, v19, v22
    v_mul_f32 v23, v19, v23
    v_mul_f32 v24, v19, v24
    v_mul_f32 v25, v19, v25
    v_mul_f32 v128, v19, v128
    v_mul_f32 v129, v19, v129
    v_mul_f32 v130, v19, v130
    v_mul_f32 v131, v19, v131
    v_mul_f32 v132, v19, v132
    v_mul_f32 v133, v19, v133
    v_mul_f32 v134, v19, v134
    v_mul_f32 v135, v19, v135
    v_mul_f32 v136, v19, v136
    v_mul_f32 v137, v19, v137
    v_mul_f32 v138, v19, v138
    v_mul_f32 v139, v19, v139
    v_mul_f32 v140, v19, v140
    v_mul_f32 v141, v19, v141
    v_mul_f32 v142, v19, v142
    v_mul_f32 v143, v19, v143
    v_mul_f32 v144, v19, v144
    v_mul_f32 v145, v19, v145
    v_mul_f32 v146, v19, v146
    v_mul_f32 v147, v19, v147
    v_mul_f32 v148, v19, v148
    v_mul_f32 v149, v19, v149
    v_mul_f32 v150, v19, v150
    v_mul_f32 v151, v19, v151
    v_mul_f32 v152, v19, v152
    v_mul_f32 v153, v19, v153
    v_mul_f32 v154, v19, v154
    v_mul_f32 v155, v19, v155
    v_mul_f32 v156, v19, v156
    v_mul_f32 v157, v19, v157
    v_mul_f32 v158, v19, v158
    v_mul_f32 v159, v19, v159
    v_mul_f32 v160, v19, v160
    v_mul_f32 v161, v19, v161
    v_mul_f32 v162, v19, v162
    v_mul_f32 v163, v19, v163
    v_mul_f32 v164, v19, v164
    v_mul_f32 v165, v19, v165
    v_mul_f32 v166, v19, v166
    v_mul_f32 v167, v19, v167
    v_mul_f32 v168, v19, v168
    v_mul_f32 v169, v19, v169
    v_mul_f32 v170, v19, v170
    v_mul_f32 v171, v19, v171
    v_mul_f32 v172, v19, v172
    v_mul_f32 v173, v19, v173
    v_mul_f32 v174, v19, v174
    v_mul_f32 v175, v19, v175
    v_mul_f32 v176, v19, v176
    v_mul_f32 v177, v19, v177
    v_mul_f32 v178, v19, v178
    v_mul_f32 v179, v19, v179
    v_mul_f32 v180, v19, v180
    v_mul_f32 v181, v19, v181
    v_mul_f32 v182, v19, v182
    v_mul_f32 v183, v19, v183
    v_mul_f32 v184, v19, v184
    v_mul_f32 v185, v19, v185
    v_mul_f32 v186, v19, v186
    v_mul_f32 v187, v19, v187
    v_mul_f32 v188, v19, v188
    v_mul_f32 v189, v19, v189
    v_mul_f32 v190, v19, v190
    v_mul_f32 v191, v19, v191
    v_exp_f32 v28, v64
    v_exp_f32 v29, v65
    v_exp_f32 v30, v66
    v_cvt_pk_bf16_f32 v96, v28, v29
    v_exp_f32 v31, v67
    v_exp_f32 v28, v68
    v_cvt_pk_bf16_f32 v97, v30, v31
    v_exp_f32 v29, v69
    v_exp_f32 v30, v70
    v_cvt_pk_bf16_f32 v98, v28, v29
    v_exp_f32 v31, v71
    v_exp_f32 v28, v72
    v_cvt_pk_bf16_f32 v99, v30, v31
    v_exp_f32 v29, v73
    v_exp_f32 v30, v74
    v_cvt_pk_bf16_f32 v100, v28, v29
    v_exp_f32 v31, v75
    v_exp_f32 v28, v76
    v_cvt_pk_bf16_f32 v101, v30, v31
    v_exp_f32 v29, v77
    v_exp_f32 v30, v78
    v_cvt_pk_bf16_f32 v102, v28, v29
    v_exp_f32 v31, v79
    s_nop 0
    v_cvt_pk_bf16_f32 v103, v30, v31
    s_nop 3
    s_branch L_back_a
L_slow_b:
    s_nop 15
    v_max3_f32 v18, v80, v81, v82
    v_max3_f32 v19, v83, v84, v85
    v_max3_f32 v18, v86, v87, v18
    v_max3_f32 v19, v88, v89, v19
    v_max3_f32 v18, v90, v91, v18
    v_max3_f32 v19, v92, v93, v19
    v_max3_f32 v18, v94, v95, v18
    v_max_f32 v18, v18, v19
    v_mov_b32 v19, v18
    s_nop 1
    v_permlane32_swap_b32 v18, v19
    v_max_f32 v18, v18, v19
    v_add_f32 v18, 0x40e00000, v18
    v_max_f32 v18, 0, v18
    v_exp_f32 v19, -v18
    v_sub_f32 v112, v112, v18
    v_sub_f32 v113, v113, v18
    v_sub_f32 v114, v114, v18
    v_sub_f32 v115, v115, v18
    v_sub_f32 v116, v116, v18
    v_sub_f32 v117, v117, v18
    v_sub_f32 v118, v118, v18
    v_sub_f32 v119, v119, v18
    v_sub_f32 v120, v120, v18
    v_sub_f32 v121, v121, v18
    v_sub_f32 v122, v122, v18
    v_sub_f32 v123, v123, v18
    v_sub_f32 v124, v124, v18
    v_sub_f32 v125, v125, v18
    v_sub_f32 v126, v126, v18
    v_sub_f32 v127, v127, v18
    v_sub_f32 v64, v64, v18
    v_sub_f32 v65, v65, v18
    v_sub_f32 v66, v66, v18
    v_sub_f32 v67, v67, v18
    v_sub_f32 v68, v68, v18
    v_sub_f32 v69, v69, v18
    v_sub_f32 v70, v70, v18
    v_sub_f32 v71, v71, v18
    v_sub_f32 v72, v72, v18
    v_sub_f32 v73, v73, v18
    v_sub_f32 v74, v74, v18
    v_sub_f32 v75, v75, v18
    v_sub_f32 v76, v76, v18
    v_sub_f32 v77, v77, v18
    v_sub_f32 v78, v78, v18
    v_sub_f32 v79, v79, v18
    v_sub_f32 v80, v80, v18
    v_sub_f32 v81, v81, v18
    v_sub_f32 v82, v82, v18
    v_sub_f32 v83, v83, v18
    v_sub_f32 v84, v84, v18
    v_sub_f32 v85, v85, v18
    v_sub_f32 v86, v86, v18
    v_sub_f32 v87, v87, v18
    v_sub_f32 v88, v88, v18
    v_sub_f32 v89, v89, v18
    v_sub_f32 v90, v90, v18
    v_sub_f32 v91, v91, v18
    v_sub_f32 v92, v92, v18
    v_sub_f32 v93, v93, v18
    v_sub_f32 v94, v94, v18
    v_sub_f32 v95, v95, v18
    v_mul_f32 v22, v19, v22
    v_mul_f32 v23, v19, v23
    v_mul_f32 v24, v19, v24
    v_mul_f32 v25, v19, v25
    v_mul_f32 v128, v19, v128
    v_mul_f32 v129, v19, v129
    v_mul_f32 v130, v19, v130
    v_mul_f32 v131, v19, v131
    v_mul_f32 v132, v19, v132
    v_mul_f32 v133, v19, v133
    v_mul_f32 v134, v19, v134
    v_mul_f32 v135, v19, v135
    v_mul_f32 v136, v19, v136
    v_mul_f32 v137, v19, v137
    v_mul_f32 v138, v19, v138
    v_mul_f32 v139, v19, v139
    v_mul_f32 v140, v19, v140
    v_mul_f32 v141, v19, v141
    v_mul_f32 v142, v19, v142
    v_mul_f32 v143, v19, v143
    v_mul_f32 v144, v19, v144
    v_mul_f32 v145, v19, v145
    v_mul_f32 v146, v19, v146
    v_mul_f32 v147, v19, v147
    v_mul_f32 v148, v19, v148
    v_mul_f32 v149, v19, v149
    v_mul_f32 v150, v19, v150
    v_mul_f32 v151, v19, v151
    v_mul_f32 v152, v19, v152
    v_mul_f32 v153, v19, v153
    v_mul_f32 v154, v19, v154
    v_mul_f32 v155, v19, v155
    v_mul_f32 v156, v19, v156
    v_mul_f32 v157, v19, v157
    v_mul_f32 v158, v19, v158
    v_mul_f32 v159, v19, v159
    v_mul_f32 v160, v19, v160
    v_mul_f32 v161, v19, v161
    v_mul_f32 v162, v19, v162
    v_mul_f32 v163, v19, v163
    v_mul_f32 v164, v19, v164
    v_mul_f32 v165, v19, v165
    v_mul_f32 v166, v19, v166
    v_mul_f32 v167, v19, v167
    v_mul_f32 v168, v19, v168
    v_mul_f32 v169, v19, v169
    v_mul_f32 v170, v19, v170
    v_mul_f32 v171, v19, v171
    v_mul_f32 v172, v19, v172
    v_mul_f32 v173, v19, v173
    v_mul_f32 v174, v19, v174
    v_mul_f32 v175, v19, v175
    v_mul_f32 v176, v19, v176
    v_mul_f32 v177, v19, v177
    v_mul_f32 v178, v19, v178
    v_mul_f32 v179, v19, v179
    v_mul_f32 v180, v19, v180
    v_mul_f32 v181, v19, v181
    v_mul_f32 v182, v19, v182
    v_mul_f32 v183, v19, v183
    v_mul_f32 v184, v19, v184
    v_mul_f32 v185, v19, v185
    v_mul_f32 v186, v19, v186
    v_mul_f32 v187, v19, v187
    v_mul_f32 v188, v19, v188
    v_mul_f32 v189, v19, v189
    v_mul_f32 v190, v19, v190
    v_mul_f32 v191, v19, v191
    v_exp_f32 v28, v80
    v_exp_f32 v29, v81
    v_exp_f32 v30, v82
    v_cvt_pk_bf16_f32 v104, v28, v29
    v_exp_f32 v31, v83
    v_exp_f32 v28, v84
    v_cvt_pk_bf16_f32 v105, v30, v31
    v_exp_f32 v29, v85
    v_exp_f32 v30, v86
    v_cvt_pk_bf16_f32 v106, v28, v29
    v_exp_f32 v31, v87
    v_exp_f32 v28, v88
    v_cvt_pk_bf16_f32 v107, v30, v31
    v_exp_f32 v29, v89
    v_exp_f32 v30, v90
    v_cvt_pk_bf16_f32 v108, v28, v29
    v_exp_f32 v31, v91
    v_exp_f32 v28, v92
    v_cvt_pk_bf16_f32 v109, v30, v31
    v_exp_f32 v29, v93
    v_exp_f32 v30, v94
    v_cvt_pk_bf16_f32 v110, v28, v29
    v_exp_f32 v31, v95
    s_nop 0
    v_cvt_pk_bf16_f32 v111, v30, v31
    s_nop 3
    s_branch L_back_b
L_slow_c:
    s_nop 15
    v_max3_f32 v18, v64, v65, v66
    v_max3_f32 v19, v67, v68, v69
    v_max3_f32 v18, v70, v71, v18
    v_max3_f32 v19, v72, v73, v19
    v_max3_f32 v18, v74, v75, v18
    v_max3_f32 v19, v76, v77, v19
    v_max3_f32 v18, v78, v79, v18
    v_max_f32 v18, v18, v19
    v_mov_b32 v19, v18
    s_nop 1
    v_permlane32_swap_b32 v18, v19
    v_max_f32 v18, v18, v19
    v_add_f32 v18, 0x40e00000, v18
    v_max_f32 v18, 0, v18
    v_exp_f32 v19, -v18
    v_sub_f32 v112, v112, v18
    v_sub_f32 v113, v113, v18
    v_sub_f32 v114, v114, v18
    v_sub_f32 v115, v115, v18
    v_sub_f32 v116, v116, v18
    v_sub_f32 v117, v117, v18
    v_sub_f32 v118, v118, v18
    v_sub_f32 v119, v119, v18
    v_sub_f32 v120, v120, v18
    v_sub_f32 v121, v121, v18
    v_sub_f32 v122, v122, v18
    v_sub_f32 v123, v123, v18
    v_sub_f32 v124, v124, v18
    v_sub_f32 v125, v125, v18
    v_sub_f32 v126, v126, v18
    v_sub_f32 v127, v127, v18
    v_sub_f32 v64, v64, v18
    v_sub_f32 v65, v65, v18
    v_sub_f32 v66, v66, v18
    v_sub_f32 v67, v67, v18
    v_sub_f32 v68, v68, v18
    v_sub_f32 v69, v69, v18
    v_sub_f32 v70, v70, v18
    v_sub_f32 v71, v71, v18
    v_sub_f32 v72, v72, v18
    v_sub_f32 v73, v73, v18
    v_sub_f32 v74, v74, v18
    v_sub_f32 v75, v75, v18
    v_sub_f32 v76, v76, v18
    v_sub_f32 v77, v77, v18
    v_sub_f32 v78, v78, v18
    v_sub_f32 v79, v79, v18
    v_sub_f32 v80, v80, v18
    v_sub_f32 v81, v81, v18
    v_sub_f32 v82, v82, v18
    v_sub_f32 v83, v83, v18
    v_sub_f32 v84, v84, v18
    v_sub_f32 v85, v85, v18
    v_sub_f32 v86, v86, v18
    v_sub_f32 v87, v87, v18
    v_sub_f32 v88, v88, v18
    v_sub_f32 v89, v89, v18
    v_sub_f32 v90, v90, v18
    v_sub_f32 v91, v91, v18
    v_sub_f32 v92, v92, v18
    v_sub_f32 v93, v93, v18
    v_sub_f32 v94, v94, v18
    v_sub_f32 v95, v95, v18
    v_mul_f32 v22, v19, v22
    v_mul_f32 v23, v19, v23
    v_mul_f32 v24, v19, v24
    v_mul_f32 v25, v19, v25
    v_mul_f32 v128, v19, v128
    v_mul_f32 v129, v19, v129
    v_mul_f32 v130, v19, v130
    v_mul_f32 v131, v19, v131
    v_mul_f32 v132, v19, v132
    v_mul_f32 v133, v19, v133
    v_mul_f32 v134, v19, v134
    v_mul_f32 v135, v19, v135
    v_mul_f32 v136, v19, v136
    v_mul_f32 v137, v19, v137
    v_mul_f32 v138, v19, v138
    v_mul_f32 v139, v19, v139
    v_mul_f32 v140, v19, v140
    v_mul_f32 v141, v19, v141
    v_mul_f32 v142, v19, v142
    v_mul_f32 v143, v19, v143
    v_mul_f32 v144, v19, v144
    v_mul_f32 v145, v19, v145
    v_mul_f32 v146, v19, v146
    v_mul_f32 v147, v19, v147
    v_mul_f32 v148, v19, v148
    v_mul_f32 v149, v19, v149
    v_mul_f32 v150, v19, v150
    v_mul_f32 v151, v19, v151
    v_mul_f32 v152, v19, v152
    v_mul_f32 v153, v19, v153
    v_mul_f32 v154, v19, v154
    v_mul_f32 v155, v19, v155
    v_mul_f32 v156, v19, v156
    v_mul_f32 v157, v19, v157
    v_mul_f32 v158, v19, v158
    v_mul_f32 v159, v19, v159
    v_mul_f32 v160, v19, v160
    v_mul_f32 v161, v19, v161
    v_mul_f32 v162, v19, v162
    v_mul_f32 v163, v19, v163
    v_mul_f32 v164, v19, v164
    v_mul_f32 v165, v19, v165
    v_mul_f32 v166, v19, v166
    v_mul_f32 v167, v19, v167
    v_mul_f32 v168, v19, v168
    v_mul_f32 v169, v19, v169
    v_mul_f32 v170, v19, v170
    v_mul_f32 v171, v19, v171
    v_mul_f32 v172, v19, v172
    v_mul_f32 v173, v19, v173
    v_mul_f32 v174, v19, v174
    v_mul_f32 v175, v19, v175
    v_mul_f32 v176, v19, v176
    v_mul_f32 v177, v19, v177
    v_mul_f32 v178, v19, v178
    v_mul_f32 v179, v19, v179
    v_mul_f32 v180, v19, v180
    v_mul_f32 v181, v19, v181
    v_mul_f32 v182, v19, v182
    v_mul_f32 v183, v19, v183
    v_mul_f32 v184, v19, v184
    v_mul_f32 v185, v19, v185
    v_mul_f32 v186, v19, v186
    v_mul_f32 v187, v19, v187
    v_mul_f32 v188, v19, v188
    v_mul_f32 v189, v19, v189
    v_mul_f32 v190, v19, v190
    v_mul_f32 v191, v19, v191
    v_exp_f32 v28, v64
    v_exp_f32 v29, v65
    v_exp_f32 v30, v66
    v_cvt_pk_bf16_f32 v96, v28, v29
    v_exp_f32 v31, v67
    v_exp_f32 v28, v68
    v_cvt_pk_bf16_f32 v97, v30, v31
    v_exp_f32 v29, v69
    v_exp_f32 v30, v70
    v_cvt_pk_bf16_f32 v98, v28, v29
    v_exp_f32 v31, v71
    v_exp_f32 v28, v72
    v_cvt_pk_bf16_f32 v99, v30, v31
    v_exp_f32 v29, v73
    v_exp_f32 v30, v74
    v_cvt_pk_bf16_f32 v100, v28, v29
    v_exp_f32 v31, v75
    v_exp_f32 v28, v76
    v_cvt_pk_bf16_f32 v101, v30, v31
    v_exp_f32 v29, v77
    v_exp_f32 v30, v78
    v_cvt_pk_bf16_f32 v102, v28, v29
    v_exp_f32 v31, v79
    s_nop 0
    v_cvt_pk_bf16_f32 v103, v30, v31
    s_nop 3
    s_branch L_back_c
L_slow_d:
    s_nop 15
    v_max3_f32 v18, v80, v81, v82
    v_max3_f32 v19, v83, v84, v85
    v_max3_f32 v18, v86, v87, v18
    v_max3_f32 v19, v88, v89, v19
    v_max3_f32 v18, v90, v91, v18
    v_max3_f32 v19, v92, v93, v19
    v_max3_f32 v18, v94, v95, v18
    v_max_f32 v18, v18, v19
    v_mov_b32 v19, v18
    s_nop 1
    v_permlane32_swap_b32 v18, v19
    v_max_f32 v18, v18, v19
    v_add_f32 v18, 0x40e00000, v18
    v_max_f32 v18, 0, v18
    v_exp_f32 v19, -v18
    v_sub_f32 v112, v112, v18
    v_sub_f32 v113, v113, v18
    v_sub_f32 v114, v114, v18
    v_sub_f32 v115, v115, v18
    v_sub_f32 v116, v116, v18
    v_sub_f32 v117, v117, v18
    v_sub_f32 v118, v118, v18
    v_sub_f32 v119, v119, v18
    v_sub_f32 v120, v120, v18
    v_sub_f32 v121, v121, v18
    v_sub_f32 v122, v122, v18
    v_sub_f32 v123, v123, v18
    v_sub_f32 v124, v124, v18
    v_sub_f32 v125, v125, v18
    v_sub_f32 v126, v126, v18
    v_sub_f32 v127, v127, v18
    v_sub_f32 v64, v64, v18
    v_sub_f32 v65, v65, v18
    v_sub_f32 v66, v66, v18
    v_sub_f32 v67, v67, v18
    v_sub_f32 v68, v68, v18
    v_sub_f32 v69, v69, v18
    v_sub_f32 v70, v70, v18
    v_sub_f32 v71, v71, v18
    v_sub_f32 v72, v72, v18
    v_sub_f32 v73, v73, v18
    v_sub_f32 v74, v74, v18
    v_sub_f32 v75, v75, v18
    v_sub_f32 v76, v76, v18
    v_sub_f32 v77, v77, v18
    v_sub_f32 v78, v78, v18
    v_sub_f32 v79, v79, v18
    v_sub_f32 v80, v80, v18
    v_sub_f32 v81, v81, v18
    v_sub_f32 v82, v82, v18
    v_sub_f32 v83, v83, v18
    v_sub_f32 v84, v84, v18
    v_sub_f32 v85, v85, v18
    v_sub_f32 v86, v86, v18
    v_sub_f32 v87, v87, v18
    v_sub_f32 v88, v88, v18
    v_sub_f32 v89, v89, v18
    v_sub_f32 v90, v90, v18
    v_sub_f32 v91, v91, v18
    v_sub_f32 v92, v92, v18
    v_sub_f32 v93, v93, v18
    v_sub_f32 v94, v94, v18
    v_sub_f32 v95, v95, v18
    v_mul_f32 v22, v19, v22
    v_mul_f32 v23, v19, v23
    v_mul_f32 v24, v19, v24
    v_mul_f32 v25, v19, v25
    v_mul_f32 v128, v19, v128
    v_mul_f32 v129, v19, v129
    v_mul_f32 v130, v19, v130
    v_mul_f32 v131, v19, v131
    v_mul_f32 v132, v19, v132
    v_mul_f32 v133, v19, v133
    v_mul_f32 v134, v19, v134
    v_mul_f32 v135, v19, v135
    v_mul_f32 v136, v19, v136
    v_mul_f32 v137, v19, v137
    v_mul_f32 v138, v19, v138
    v_mul_f32 v139, v19, v139
    v_mul_f32 v140, v19, v140
    v_mul_f32 v141, v19, v141
    v_mul_f32 v142, v19, v142
    v_mul_f32 v143, v19, v143
    v_mul_f32 v144, v19, v144
    v_mul_f32 v145, v19, v145
    v_mul_f32 v146, v19, v146
    v_mul_f32 v147, v19, v147
    v_mul_f32 v148, v19, v148
    v_mul_f32 v149, v19, v149
    v_mul_f32 v150, v19, v150
    v_mul_f32 v151, v19, v151
    v_mul_f32 v152, v19, v152
    v_mul_f32 v153, v19, v153
    v_mul_f32 v154, v19, v154
    v_mul_f32 v155, v19, v155
    v_mul_f32 v156, v19, v156
    v_mul_f32 v157, v19, v157
    v_mul_f32 v158, v19, v158
    v_mul_f32 v159, v19, v159
    v_mul_f32 v160, v19, v160
    v_mul_f32 v161, v19, v161
    v_mul_f32 v162, v19, v162
    v_mul_f32 v163, v19, v163
    v_mul_f32 v164, v19, v164
    v_mul_f32 v165, v19, v165
    v_mul_f32 v166, v19, v166
    v_mul_f32 v167, v19, v167
    v_mul_f32 v168, v19, v168
    v_mul_f32 v169, v19, v169
    v_mul_f32 v170, v19, v170
    v_mul_f32 v171, v19, v171
    v_mul_f32 v172, v19, v172
    v_mul_f32 v173, v19, v173
    v_mul_f32 v174, v19, v174
    v_mul_f32 v175, v19, v175
    v_mul_f32 v176, v19, v176
    v_mul_f32 v177, v19, v177
    v_mul_f32 v178, v19, v178
    v_mul_f32 v179, v19, v179
    v_mul_f32 v180, v19, v180
    v_mul_f32 v181, v19, v181
    v_mul_f32 v182, v19, v182
    v_mul_f32 v183, v19, v183
    v_mul_f32 v184, v19, v184
    v_mul_f32 v185, v19, v185
    v_mul_f32 v186, v19, v186
    v_mul_f32 v187, v19, v187
    v_mul_f32 v188, v19, v188
    v_mul_f32 v189, v19, v189
    v_mul_f32 v190, v19, v190
    v_mul_f32 v191, v19, v191
    v_exp_f32 v28, v80
    v_exp_f32 v29, v81
    v_exp_f32 v30, v82
    v_cvt_pk_bf16_f32 v104, v28, v29
    v_exp_f32 v31, v83
    v_exp_f32 v28, v84
    v_cvt_pk_bf16_f32 v105, v30, v31
    v_exp_f32 v29, v85
    v_exp_f32 v30, v86
    v_cvt_pk_bf16_f32 v106, v28, v29
    v_exp_f32 v31, v87
    v_exp_f32 v28, v88
    v_cvt_pk_bf16_f32 v107, v30, v31
    v_exp_f32 v29, v89
    v_exp_f32 v30, v90
    v_cvt_pk_bf16_f32 v108, v28, v29
    v_exp_f32 v31, v91
    v_exp_f32 v28, v92
    v_cvt_pk_bf16_f32 v109, v30, v31
    v_exp_f32 v29, v93
    v_exp_f32 v30, v94
    v_cvt_pk_bf16_f32 v110, v28, v29
    v_exp_f32 v31, v95
    s_nop 0
    v_cvt_pk_bf16_f32 v111, v30, v31
    s_nop 3
    s_branch L_back_d
L_codeend:
.section .rodata,"a"
.p2align 6
.amdhsa_kernel standalone__gqa_block_cached__near_ridge_kernel
  .amdhsa_next_free_vgpr 404
  .amdhsa_next_free_sgpr 100
  .amdhsa_accum_offset 256
  .amdhsa_group_segment_fixed_size 0
  .amdhsa_kernarg_size 64
  .amdhsa_user_sgpr_count 2
  .amdhsa_user_sgpr_kernarg_segment_ptr 1
  .amdhsa_system_sgpr_workgroup_id_x 1
.end_amdhsa_kernel
```
